```python
import torch

def _softmax(x, axis=-1):
    return torch.softmax(x, dim=axis)
def _gelu(x):
    return torch.nn.functional.gelu(x, approximate="tanh")
def _silu(x):
    return torch.nn.functional.silu(x)
def _sigmoid(x):
    return torch.sigmoid(x)
def _layernorm(x, axis=-1, eps=1e-5):
    m = x.mean(dim=axis, keepdim=True)
    v = x.var(dim=axis, keepdim=True, unbiased=False)
    return (x - m) / torch.sqrt(v + eps)
def _scatter_add(tgt, idx, src, axis=0):
    return tgt.clone().index_add_(axis, idx, src)
def _segment_sum(src, seg, n):
    out = torch.zeros((n,) + src.shape[1:], dtype=src.dtype)
    return out.index_add_(0, seg, src)
def _pad(x, pw):
    flat = tuple(v for pair in reversed(pw) for v in pair)
    return torch.nn.functional.pad(x, flat)

kernel_name = 'recurrent_scan__ssm_conv_s4d__dense_activation_mish__prompt'

def setup_inputs():

    _w = (lambda a: (lambda t: t.to(torch.bfloat16) if t.is_floating_point() else t)(torch.as_tensor(a)))
    def _A_setup():
        Bsz, L, D, N = 1, 2048, 448, 256
        return {
            "u": _w((lambda *s: torch.randn(*s, dtype=torch.bfloat16) * 0.05)(Bsz, L, D)),
            "log_A_real": _w((lambda *s: torch.randn(*s, dtype=torch.bfloat16) * 3.2)(D, N) * 0.5),
            "A_imag": _w((lambda *s: torch.randn(*s, dtype=torch.bfloat16) * 0.2)(D, N) * 3.14),
            "C_real": _w((lambda *s: torch.randn(*s, dtype=torch.bfloat16) * 0.8)(D, N) / N ** 0.5),
            "C_imag": _w((lambda *s: torch.randn(*s, dtype=torch.bfloat16) * 0.8)(D, N) / N ** 0.5),
            "log_dt": _w((lambda *s: torch.randn(*s, dtype=torch.bfloat16) * 0.2)(D) * 0.5 - 4.0),
            "D_skip": _w((lambda *s: torch.randn(*s, dtype=torch.bfloat16) * 0.2)(D)),
        }
    _A_in = _A_setup()

    def _B_setup():
        B, S, D, F = 1, 2048, 448, 1792
        return {
            "x": _w((lambda *s: torch.randn(*s, dtype=torch.bfloat16) * 0.05)(B, S, D)),
            "w1": _w((lambda *s: torch.randn(*s, dtype=torch.bfloat16) * 0.8)(D, F) * (D ** -0.5)),
            "b1": _w((lambda *s: torch.randn(*s, dtype=torch.bfloat16) * 0.4)(F)),
            "w2": _w((lambda *s: torch.randn(*s, dtype=torch.bfloat16) * 0.1)(F, D) * (F ** -0.5)),
        }
    _B_in = _B_setup()

    return {
        "A_u": _A_in["u"],
        "A_log_A_real": _A_in["log_A_real"],
        "A_A_imag": _A_in["A_imag"],
        "A_C_real": _A_in["C_real"],
        "A_C_imag": _A_in["C_imag"],
        "A_log_dt": _A_in["log_dt"],
        "A_D_skip": _A_in["D_skip"],
        "B_x": _B_in["x"],
        "B_w1": _B_in["w1"],
        "B_b1": _B_in["b1"],
        "B_w2": _B_in["w2"],
    }

def reference(A_u, A_log_A_real, A_A_imag, A_C_real, A_C_imag, A_log_dt, A_D_skip, B_x, B_w1, B_b1, B_w2):
    def _A_ref(u, log_A_real, A_imag, C_real, C_imag, log_dt, D_skip):
        L = u.shape[1]
        dt = torch.exp(log_dt)
        A = -torch.exp(log_A_real) + 1j * A_imag
        C = (C_real + 1j * C_imag) * dt[:, None]
        pos = (lambda x, dt: x.to(dt))(torch.arange(L), log_dt.dtype)
        P = torch.exp((A * dt[:, None])[:, :, None] * pos[None, None, :])
        K = 2.0 * torch.einsum("dn,dnl->dl", C, P).real
        L2 = 2 * L
        u_t = (lambda x, *d: x.permute(*d))(u, 0, 2, 1)
        Kf = (lambda x, *a, **k: torch.fft.rfft(x.float(), *a, **k))(K, L2)
        Uf = (lambda x, *a, **k: torch.fft.rfft(x.float(), *a, **k))(u_t, L2)
        y = (lambda x, *a, **k: torch.fft.irfft(x, *a, **k).to(torch.bfloat16))(Uf * Kf[None, :, :], L2)[:, :, :L]
        y = (lambda x, *d: x.permute(*d))(y, 0, 2, 1)
        return y + u * D_skip[None, None, :]

    def _B_ref(x, w1, b1, w2):
        h = torch.einsum("bsd,df->bsf", x, w1) + b1
        sp = torch.log1p(torch.exp(-torch.abs(h))) + torch.where(h > 0, h, torch.zeros_like(h))
        act = h * torch.tanh(sp)
        return torch.einsum("bsf,fd->bsd", act, w2)

    x = A_u
    xn = _layernorm(x, axis=-1)
    s = _A_ref(xn, A_log_A_real, A_A_imag, A_C_real, A_C_imag, A_log_dt, A_D_skip)
    g = _silu(_B_ref(xn, B_w1, B_b1, B_w2))
    return x + s * g
```

```asm
; @launch kernel=p0_kernel grid=(512,1,1) block=(256,1,1) lds=81920
; @launch kernel=p1_kernel grid=(448,1,1) block=(256,1,1) lds=57344
.amdgcn_target "amdgcn-amd-amdhsa--gfx950"
.text
.globl p0_kernel
.p2align 8
.type p0_kernel,@function
p0_kernel:
    s_cmp_lt_u32 s2, 224
    s_cbranch_scc0 L0_other
    s_mov_b32 s48, s2

    s_load_dwordx2 s[4:5], s[0:1], 104
    s_load_dwordx2 s[6:7], s[0:1], 72
    s_load_dwordx2 s[50:51], s[0:1], 0
    s_load_dwordx2 s[52:53], s[0:1], 64
    v_and_b32 v1, 63, v0
    v_lshrrev_b32 v2, 6, v0
    s_nop 0
    v_readfirstlane_b32 s8, v2

    s_and_b32 s9, s48, 15
    s_lshr_b32 s10, s48, 4
    s_and_b32 s32, s8, 1
    s_lshr_b32 s33, s8, 1
    v_lshrrev_b32 v4, 4, v1
    v_and_b32 v5, 15, v1
    v_lshlrev_b32 v6, 2, v4
    v_xor_b32 v5, v5, v6
    v_lshlrev_b32 v5, 4, v5
    v_mul_u32_u24 v6, 3584, v4
    v_add_u32 v176, v5, v6
    v_lshrrev_b32 v5, 2, v1
    v_and_b32 v6, 3, v1
    v_xor_b32 v6, v6, v4
    v_mul_u32_u24 v5, 896, v5
    v_lshl_add_u32 v177, v6, 4, v5
    s_mul_i32 s28, s8, 28672
    s_lshl_b32 s11, s10, 8
    s_add_u32 s28, s28, s11
    s_add_u32 s29, s28, 14336
    s_lshl_b32 s30, s9, 7
    s_lshl_b32 s11, s8, 5
    s_add_u32 s30, s30, s11
    s_mul_i32 s30, s30, 896
    s_add_u32 s31, s30, 14336
    s_lshl_b32 s34, s8, 11
    s_add_u32 s34, s34, 0
    s_waitcnt lgkmcnt(0)

    s_mov_b32 s12, s52
    s_mov_b32 s13, s53
    s_mov_b32 s14, 1605632
    s_mov_b32 s15, 0x00020000
    s_mov_b32 s16, s50
    s_mov_b32 s17, s51
    s_mov_b32 s18, 1835008
    s_mov_b32 s19, 0x00020000
    s_add_u32 m0, s34, 0
    s_nop 0
    buffer_load_dwordx4 v176, s[12:15], s28 offen lds
    s_add_u32 m0, s34, 1024
    s_add_u32 s28, s28, 114688
    buffer_load_dwordx4 v176, s[12:15], s29 offen lds
    s_add_u32 m0, s34, 8192
    s_add_u32 s29, s29, 114688
    buffer_load_dwordx4 v177, s[16:19], s30 offen lds
    s_add_u32 m0, s34, 9216
    s_add_u32 s30, s30, 64
    buffer_load_dwordx4 v177, s[16:19], s31 offen lds
    s_add_u32 s31, s31, 64
    s_add_u32 m0, s34, 16384
    s_nop 0
    buffer_load_dwordx4 v176, s[12:15], s28 offen lds
    s_add_u32 m0, s34, 17408
    s_add_u32 s28, s28, 114688
    buffer_load_dwordx4 v176, s[12:15], s29 offen lds
    s_add_u32 m0, s34, 24576
    s_add_u32 s29, s29, 114688
    buffer_load_dwordx4 v177, s[16:19], s30 offen lds
    s_add_u32 m0, s34, 25600
    s_add_u32 s30, s30, 64
    buffer_load_dwordx4 v177, s[16:19], s31 offen lds
    s_add_u32 s31, s31, 64
    s_add_u32 m0, s34, 32768
    s_nop 0
    buffer_load_dwordx4 v176, s[12:15], s28 offen lds
    s_add_u32 m0, s34, 33792
    s_add_u32 s28, s28, 114688
    buffer_load_dwordx4 v176, s[12:15], s29 offen lds
    s_add_u32 m0, s34, 40960
    s_add_u32 s29, s29, 114688
    buffer_load_dwordx4 v177, s[16:19], s30 offen lds
    s_add_u32 m0, s34, 41984
    s_add_u32 s30, s30, 64
    buffer_load_dwordx4 v177, s[16:19], s31 offen lds
    s_add_u32 s31, s31, 64
    s_add_u32 m0, s34, 49152
    s_nop 0
    buffer_load_dwordx4 v176, s[12:15], s28 offen lds
    s_add_u32 m0, s34, 50176
    s_add_u32 s28, s28, 114688
    buffer_load_dwordx4 v176, s[12:15], s29 offen lds
    s_add_u32 m0, s34, 57344
    s_add_u32 s29, s29, 114688
    buffer_load_dwordx4 v177, s[16:19], s30 offen lds
    s_add_u32 m0, s34, 58368
    s_add_u32 s30, s30, 64
    buffer_load_dwordx4 v177, s[16:19], s31 offen lds
    s_add_u32 s31, s31, 64
    s_mov_b32 s44, 0x3fb8aa3b
    s_mov_b32 s45, 0x3fb8aa3b
    s_mov_b32 s46, 0x3f803f80

    s_add_u32 s20, s4, 10551296
    s_addc_u32 s21, s5, 0
    s_mov_b32 s22, 7340032
    s_mov_b32 s23, 0x00020000
    s_mov_b32 s24, s6
    s_mov_b32 s25, s7
    s_mov_b32 s26, 3584
    s_mov_b32 s27, 0x00020000
    s_lshl_b32 s35, s10, 8
    s_lshl_b32 s36, s32, 7
    s_add_u32 s35, s35, s36
    s_lshl_b32 s36, s33, 6
    s_add_u32 s37, s35, s36
    s_xor_b32 s36, s36, 64
    s_add_u32 s38, s35, s36
    v_lshrrev_b32 v7, 5, v1
    v_lshlrev_b32 v8, 3, v7

    v_mov_b32 v190, v8
    v_and_b32 v5, 15, v1
    v_lshrrev_b32 v6, 2, v5
    v_and_b32 v9, 3, v5
    v_lshl_add_u32 v10, v7, 3, v6
    v_lshlrev_b32 v10, 8, v10
    v_and_b32 v11, 1, v4
    v_lshl_add_u32 v10, v11, 5, v10
    v_lshl_add_u32 v10, v9, 3, v10
    v_add_u32 v10, 0, v10
    s_lshl_b32 s39, s32, 1
    s_add_u32 s40, s39, s33
    s_xor_b32 s41, s33, 1
    s_add_u32 s41, s41, s39
    v_xor_b32 v11, s40, v6
    v_lshl_add_u32 v178, v11, 6, v10
    v_xor_b32 v11, s41, v6
    v_lshl_add_u32 v179, v11, 6, v10

    v_and_b32 v5, 31, v1
    v_lshrrev_b32 v6, 2, v5
    v_and_b32 v6, 3, v6
    v_xor_b32 v6, v6, v7
    v_lshlrev_b32 v6, 4, v6
    v_lshl_add_u32 v6, v5, 6, v6
    v_add_u32 v6, 8192, v6
    s_lshl_b32 s39, s33, 1
    s_add_u32 s42, s39, s32
    s_xor_b32 s43, s32, 1
    s_add_u32 s43, s43, s39
    s_lshl_b32 s47, s42, 11
    v_add_u32 v180, s47, v6
    v_xor_b32 v181, 32, v180
    s_lshl_b32 s47, s43, 11
    v_add_u32 v182, s47, v6
    v_xor_b32 v183, 32, v182

    v_add_u32 v184, 32768, v178
    v_add_u32 v185, 32768, v179
    v_add_u32 v186, 32768, v180
    v_add_u32 v187, 32768, v181
    v_add_u32 v188, 32768, v182
    v_add_u32 v189, 32768, v183
    v_and_b32 v5, 15, v1
    v_and_b32 v6, 1, v4
    v_cmp_eq_u32 vcc, v5, v6
    v_mov_b32 v5, s46
    s_nop 0
    v_cndmask_b32 v232, 0, v5, vcc
    v_cndmask_b32 v233, 0, v5, vcc
    v_cndmask_b32 v234, 0, v5, vcc
    v_cndmask_b32 v235, 0, v5, vcc

    s_waitcnt vmcnt(12)
    s_barrier
    ds_read_b64_tr_b16 v[72:73], v178 offset:0
    ds_read_b64_tr_b16 v[74:75], v178 offset:1024
    ds_read_b64_tr_b16 v[76:77], v179 offset:0
    ds_read_b64_tr_b16 v[78:79], v179 offset:1024
    ds_read_b128 v[80:83], v180 offset:0
    ds_read_b128 v[84:87], v182 offset:0
    ds_read_b64_tr_b16 v[88:89], v178 offset:4096
    ds_read_b64_tr_b16 v[90:91], v178 offset:5120
    ds_read_b64_tr_b16 v[92:93], v179 offset:4096
    ds_read_b64_tr_b16 v[94:95], v179 offset:5120
    ds_read_b128 v[96:99], v181 offset:0
    ds_read_b128 v[100:103], v183 offset:0
    s_waitcnt lgkmcnt(0)
    s_waitcnt vmcnt(8)
    s_barrier
    v_mfma_f32_32x32x16_bf16 v[8:23], v[72:75], v[80:83], 0
    ds_read_b64_tr_b16 v[104:105], v178 offset:16384
    ds_read_b64_tr_b16 v[106:107], v178 offset:17408
    v_mfma_f32_32x32x16_bf16 v[24:39], v[72:75], v[84:87], 0
    ds_read_b64_tr_b16 v[108:109], v179 offset:16384
    ds_read_b64_tr_b16 v[110:111], v179 offset:17408
    v_mfma_f32_16x16x32_bf16 v[224:227], v[232:235], v[80:83], 0
    s_add_u32 m0, s34, 65536
    s_nop 0
    buffer_load_dwordx4 v176, s[12:15], s28 offen lds
    v_mfma_f32_16x16x32_bf16 v[228:231], v[232:235], v[72:75], 0
    v_mfma_f32_32x32x16_bf16 v[40:55], v[76:79], v[80:83], 0
    ds_read_b128 v[112:115], v180 offset:16384
    ds_read_b128 v[116:119], v182 offset:16384
    v_mfma_f32_32x32x16_bf16 v[56:71], v[76:79], v[84:87], 0
    ds_read_b64_tr_b16 v[120:121], v178 offset:20480
    ds_read_b64_tr_b16 v[122:123], v178 offset:21504
    v_mfma_f32_32x32x16_bf16 v[208:223], v[80:83], v[80:83], 0
    ds_read_b64_tr_b16 v[124:125], v179 offset:20480
    ds_read_b64_tr_b16 v[126:127], v179 offset:21504
    s_add_u32 m0, s34, 66560
    s_add_u32 s28, s28, 114688
    buffer_load_dwordx4 v176, s[12:15], s29 offen lds
    v_mfma_f32_32x32x16_bf16 v[8:23], v[88:91], v[96:99], v[8:23]
    ds_read_b128 v[128:131], v181 offset:16384
    ds_read_b128 v[132:135], v183 offset:16384
    v_mfma_f32_32x32x16_bf16 v[24:39], v[88:91], v[100:103], v[24:39]
    v_mfma_f32_16x16x32_bf16 v[224:227], v[232:235], v[96:99], v[224:227]
    s_add_u32 m0, s34, 73728
    s_add_u32 s29, s29, 114688
    buffer_load_dwordx4 v177, s[16:19], s30 offen lds
    v_mfma_f32_16x16x32_bf16 v[228:231], v[232:235], v[88:91], v[228:231]
    v_mfma_f32_32x32x16_bf16 v[40:55], v[92:95], v[96:99], v[40:55]
    v_mfma_f32_32x32x16_bf16 v[56:71], v[92:95], v[100:103], v[56:71]
    s_add_u32 m0, s34, 74752
    s_add_u32 s30, s30, 64
    buffer_load_dwordx4 v177, s[16:19], s31 offen lds
    s_add_u32 s31, s31, 64
    v_mfma_f32_32x32x16_bf16 v[208:223], v[96:99], v[96:99], v[208:223]
    s_waitcnt lgkmcnt(0)
    s_waitcnt vmcnt(8)
    s_barrier
    v_mfma_f32_32x32x16_bf16 v[8:23], v[104:107], v[112:115], v[8:23]
    ds_read_b64_tr_b16 v[72:73], v184 offset:0
    ds_read_b64_tr_b16 v[74:75], v184 offset:1024
    v_mfma_f32_32x32x16_bf16 v[24:39], v[104:107], v[116:119], v[24:39]
    ds_read_b64_tr_b16 v[76:77], v185 offset:0
    ds_read_b64_tr_b16 v[78:79], v185 offset:1024
    v_mfma_f32_16x16x32_bf16 v[224:227], v[232:235], v[112:115], v[224:227]
    s_add_u32 m0, s34, 0
    s_nop 0
    buffer_load_dwordx4 v176, s[12:15], s28 offen lds
    v_mfma_f32_16x16x32_bf16 v[228:231], v[232:235], v[104:107], v[228:231]
    v_mfma_f32_32x32x16_bf16 v[40:55], v[108:111], v[112:115], v[40:55]
    ds_read_b128 v[80:83], v186 offset:0
    ds_read_b128 v[84:87], v188 offset:0
    v_mfma_f32_32x32x16_bf16 v[56:71], v[108:111], v[116:119], v[56:71]
    ds_read_b64_tr_b16 v[88:89], v184 offset:4096
    ds_read_b64_tr_b16 v[90:91], v184 offset:5120
    v_mfma_f32_32x32x16_bf16 v[208:223], v[112:115], v[112:115], v[208:223]
    ds_read_b64_tr_b16 v[92:93], v185 offset:4096
    ds_read_b64_tr_b16 v[94:95], v185 offset:5120
    s_add_u32 m0, s34, 1024
    s_add_u32 s28, s28, 114688
    buffer_load_dwordx4 v176, s[12:15], s29 offen lds
    v_mfma_f32_32x32x16_bf16 v[8:23], v[120:123], v[128:131], v[8:23]
    ds_read_b128 v[96:99], v187 offset:0
    ds_read_b128 v[100:103], v189 offset:0
    v_mfma_f32_32x32x16_bf16 v[24:39], v[120:123], v[132:135], v[24:39]
    v_mfma_f32_16x16x32_bf16 v[224:227], v[232:235], v[128:131], v[224:227]
    s_add_u32 m0, s34, 8192
    s_add_u32 s29, s29, 114688
    buffer_load_dwordx4 v177, s[16:19], s30 offen lds
    v_mfma_f32_16x16x32_bf16 v[228:231], v[232:235], v[120:123], v[228:231]
    v_mfma_f32_32x32x16_bf16 v[40:55], v[124:127], v[128:131], v[40:55]
    v_mfma_f32_32x32x16_bf16 v[56:71], v[124:127], v[132:135], v[56:71]
    s_add_u32 m0, s34, 9216
    s_add_u32 s30, s30, 64
    buffer_load_dwordx4 v177, s[16:19], s31 offen lds
    s_add_u32 s31, s31, 64
    v_mfma_f32_32x32x16_bf16 v[208:223], v[128:131], v[128:131], v[208:223]
    s_waitcnt lgkmcnt(0)
    s_waitcnt vmcnt(8)
    s_barrier
    v_mfma_f32_32x32x16_bf16 v[8:23], v[72:75], v[80:83], v[8:23]
    ds_read_b64_tr_b16 v[104:105], v184 offset:16384
    ds_read_b64_tr_b16 v[106:107], v184 offset:17408
    v_mfma_f32_32x32x16_bf16 v[24:39], v[72:75], v[84:87], v[24:39]
    ds_read_b64_tr_b16 v[108:109], v185 offset:16384
    ds_read_b64_tr_b16 v[110:111], v185 offset:17408
    v_mfma_f32_16x16x32_bf16 v[224:227], v[232:235], v[80:83], v[224:227]
    s_add_u32 m0, s34, 16384
    s_nop 0
    buffer_load_dwordx4 v176, s[12:15], s28 offen lds
    v_mfma_f32_16x16x32_bf16 v[228:231], v[232:235], v[72:75], v[228:231]
    v_mfma_f32_32x32x16_bf16 v[40:55], v[76:79], v[80:83], v[40:55]
    ds_read_b128 v[112:115], v186 offset:16384
    ds_read_b128 v[116:119], v188 offset:16384
    v_mfma_f32_32x32x16_bf16 v[56:71], v[76:79], v[84:87], v[56:71]
    ds_read_b64_tr_b16 v[120:121], v184 offset:20480
    ds_read_b64_tr_b16 v[122:123], v184 offset:21504
    v_mfma_f32_32x32x16_bf16 v[208:223], v[80:83], v[80:83], v[208:223]
    ds_read_b64_tr_b16 v[124:125], v185 offset:20480
    ds_read_b64_tr_b16 v[126:127], v185 offset:21504
    s_add_u32 m0, s34, 17408
    s_add_u32 s28, s28, 114688
    buffer_load_dwordx4 v176, s[12:15], s29 offen lds
    v_mfma_f32_32x32x16_bf16 v[8:23], v[88:91], v[96:99], v[8:23]
    ds_read_b128 v[128:131], v187 offset:16384
    ds_read_b128 v[132:135], v189 offset:16384
    v_mfma_f32_32x32x16_bf16 v[24:39], v[88:91], v[100:103], v[24:39]
    v_mfma_f32_16x16x32_bf16 v[224:227], v[232:235], v[96:99], v[224:227]
    s_add_u32 m0, s34, 24576
    s_add_u32 s29, s29, 114688
    buffer_load_dwordx4 v177, s[16:19], s30 offen lds
    v_mfma_f32_16x16x32_bf16 v[228:231], v[232:235], v[88:91], v[228:231]
    v_mfma_f32_32x32x16_bf16 v[40:55], v[92:95], v[96:99], v[40:55]
    v_mfma_f32_32x32x16_bf16 v[56:71], v[92:95], v[100:103], v[56:71]
    s_add_u32 m0, s34, 25600
    s_add_u32 s30, s30, 64
    buffer_load_dwordx4 v177, s[16:19], s31 offen lds
    s_add_u32 s31, s31, 64
    v_mfma_f32_32x32x16_bf16 v[208:223], v[96:99], v[96:99], v[208:223]
    s_waitcnt lgkmcnt(0)
    s_waitcnt vmcnt(8)
    s_barrier
    v_mfma_f32_32x32x16_bf16 v[8:23], v[104:107], v[112:115], v[8:23]
    ds_read_b64_tr_b16 v[72:73], v184 offset:32768
    ds_read_b64_tr_b16 v[74:75], v184 offset:33792
    v_mfma_f32_32x32x16_bf16 v[24:39], v[104:107], v[116:119], v[24:39]
    ds_read_b64_tr_b16 v[76:77], v185 offset:32768
    ds_read_b64_tr_b16 v[78:79], v185 offset:33792
    v_mfma_f32_16x16x32_bf16 v[224:227], v[232:235], v[112:115], v[224:227]
    s_add_u32 m0, s34, 32768
    s_nop 0
    buffer_load_dwordx4 v176, s[12:15], s28 offen lds
    v_mfma_f32_16x16x32_bf16 v[228:231], v[232:235], v[104:107], v[228:231]
    v_mfma_f32_32x32x16_bf16 v[40:55], v[108:111], v[112:115], v[40:55]
    ds_read_b128 v[80:83], v186 offset:32768
    ds_read_b128 v[84:87], v188 offset:32768
    v_mfma_f32_32x32x16_bf16 v[56:71], v[108:111], v[116:119], v[56:71]
    ds_read_b64_tr_b16 v[88:89], v184 offset:36864
    ds_read_b64_tr_b16 v[90:91], v184 offset:37888
    v_mfma_f32_32x32x16_bf16 v[208:223], v[112:115], v[112:115], v[208:223]
    ds_read_b64_tr_b16 v[92:93], v185 offset:36864
    ds_read_b64_tr_b16 v[94:95], v185 offset:37888
    s_add_u32 m0, s34, 33792
    s_add_u32 s28, s28, 114688
    buffer_load_dwordx4 v176, s[12:15], s29 offen lds
    v_mfma_f32_32x32x16_bf16 v[8:23], v[120:123], v[128:131], v[8:23]
    ds_read_b128 v[96:99], v187 offset:32768
    ds_read_b128 v[100:103], v189 offset:32768
    v_mfma_f32_32x32x16_bf16 v[24:39], v[120:123], v[132:135], v[24:39]
    v_mfma_f32_16x16x32_bf16 v[224:227], v[232:235], v[128:131], v[224:227]
    s_add_u32 m0, s34, 40960
    s_add_u32 s29, s29, 114688
    buffer_load_dwordx4 v177, s[16:19], s30 offen lds
    v_mfma_f32_16x16x32_bf16 v[228:231], v[232:235], v[120:123], v[228:231]
    v_mfma_f32_32x32x16_bf16 v[40:55], v[124:127], v[128:131], v[40:55]
    v_mfma_f32_32x32x16_bf16 v[56:71], v[124:127], v[132:135], v[56:71]
    s_add_u32 m0, s34, 41984
    s_add_u32 s30, s30, 64
    buffer_load_dwordx4 v177, s[16:19], s31 offen lds
    s_add_u32 s31, s31, 64
    v_mfma_f32_32x32x16_bf16 v[208:223], v[128:131], v[128:131], v[208:223]
    s_waitcnt lgkmcnt(0)
    s_waitcnt vmcnt(8)
    s_barrier
    v_mfma_f32_32x32x16_bf16 v[8:23], v[72:75], v[80:83], v[8:23]
    ds_read_b64_tr_b16 v[104:105], v178 offset:0
    ds_read_b64_tr_b16 v[106:107], v178 offset:1024
    v_mfma_f32_32x32x16_bf16 v[24:39], v[72:75], v[84:87], v[24:39]
    ds_read_b64_tr_b16 v[108:109], v179 offset:0
    ds_read_b64_tr_b16 v[110:111], v179 offset:1024
    v_mfma_f32_16x16x32_bf16 v[224:227], v[232:235], v[80:83], v[224:227]
    s_add_u32 m0, s34, 49152
    s_nop 0
    buffer_load_dwordx4 v176, s[12:15], s28 offen lds
    v_mfma_f32_16x16x32_bf16 v[228:231], v[232:235], v[72:75], v[228:231]
    v_mfma_f32_32x32x16_bf16 v[40:55], v[76:79], v[80:83], v[40:55]
    ds_read_b128 v[112:115], v180 offset:0
    ds_read_b128 v[116:119], v182 offset:0
    v_mfma_f32_32x32x16_bf16 v[56:71], v[76:79], v[84:87], v[56:71]
    ds_read_b64_tr_b16 v[120:121], v178 offset:4096
    ds_read_b64_tr_b16 v[122:123], v178 offset:5120
    v_mfma_f32_32x32x16_bf16 v[208:223], v[80:83], v[80:83], v[208:223]
    ds_read_b64_tr_b16 v[124:125], v179 offset:4096
    ds_read_b64_tr_b16 v[126:127], v179 offset:5120
    s_add_u32 m0, s34, 50176
    s_add_u32 s28, s28, 114688
    buffer_load_dwordx4 v176, s[12:15], s29 offen lds
    v_mfma_f32_32x32x16_bf16 v[8:23], v[88:91], v[96:99], v[8:23]
    ds_read_b128 v[128:131], v181 offset:0
    ds_read_b128 v[132:135], v183 offset:0
    v_mfma_f32_32x32x16_bf16 v[24:39], v[88:91], v[100:103], v[24:39]
    v_mfma_f32_16x16x32_bf16 v[224:227], v[232:235], v[96:99], v[224:227]
    s_add_u32 m0, s34, 57344
    s_add_u32 s29, s29, 114688
    buffer_load_dwordx4 v177, s[16:19], s30 offen lds
    v_mfma_f32_16x16x32_bf16 v[228:231], v[232:235], v[88:91], v[228:231]
    v_mfma_f32_32x32x16_bf16 v[40:55], v[92:95], v[96:99], v[40:55]
    v_mfma_f32_32x32x16_bf16 v[56:71], v[92:95], v[100:103], v[56:71]
    s_add_u32 m0, s34, 58368
    s_add_u32 s30, s30, 64
    buffer_load_dwordx4 v177, s[16:19], s31 offen lds
    s_add_u32 s31, s31, 64
    v_mfma_f32_32x32x16_bf16 v[208:223], v[96:99], v[96:99], v[208:223]
    s_waitcnt lgkmcnt(0)
    s_waitcnt vmcnt(8)
    s_barrier
    v_mfma_f32_32x32x16_bf16 v[8:23], v[104:107], v[112:115], v[8:23]
    ds_read_b64_tr_b16 v[72:73], v178 offset:16384
    ds_read_b64_tr_b16 v[74:75], v178 offset:17408
    v_mfma_f32_32x32x16_bf16 v[24:39], v[104:107], v[116:119], v[24:39]
    ds_read_b64_tr_b16 v[76:77], v179 offset:16384
    ds_read_b64_tr_b16 v[78:79], v179 offset:17408
    v_mfma_f32_16x16x32_bf16 v[224:227], v[232:235], v[112:115], v[224:227]
    s_add_u32 m0, s34, 65536
    s_nop 0
    buffer_load_dwordx4 v176, s[12:15], s28 offen lds
    v_mfma_f32_16x16x32_bf16 v[228:231], v[232:235], v[104:107], v[228:231]
    v_mfma_f32_32x32x16_bf16 v[40:55], v[108:111], v[112:115], v[40:55]
    ds_read_b128 v[80:83], v180 offset:16384
    ds_read_b128 v[84:87], v182 offset:16384
    v_mfma_f32_32x32x16_bf16 v[56:71], v[108:111], v[116:119], v[56:71]
    ds_read_b64_tr_b16 v[88:89], v178 offset:20480
    ds_read_b64_tr_b16 v[90:91], v178 offset:21504
    v_mfma_f32_32x32x16_bf16 v[208:223], v[112:115], v[112:115], v[208:223]
    ds_read_b64_tr_b16 v[92:93], v179 offset:20480
    ds_read_b64_tr_b16 v[94:95], v179 offset:21504
    s_add_u32 m0, s34, 66560
    s_add_u32 s28, s28, 114688
    buffer_load_dwordx4 v176, s[12:15], s29 offen lds
    v_mfma_f32_32x32x16_bf16 v[8:23], v[120:123], v[128:131], v[8:23]
    ds_read_b128 v[96:99], v181 offset:16384
    ds_read_b128 v[100:103], v183 offset:16384
    v_mfma_f32_32x32x16_bf16 v[24:39], v[120:123], v[132:135], v[24:39]
    v_mfma_f32_16x16x32_bf16 v[224:227], v[232:235], v[128:131], v[224:227]
    s_add_u32 m0, s34, 73728
    s_add_u32 s29, s29, 114688
    buffer_load_dwordx4 v177, s[16:19], s30 offen lds
    v_mfma_f32_16x16x32_bf16 v[228:231], v[232:235], v[120:123], v[228:231]
    v_mfma_f32_32x32x16_bf16 v[40:55], v[124:127], v[128:131], v[40:55]
    v_mfma_f32_32x32x16_bf16 v[56:71], v[124:127], v[132:135], v[56:71]
    s_add_u32 m0, s34, 74752
    s_add_u32 s30, s30, 64
    buffer_load_dwordx4 v177, s[16:19], s31 offen lds
    s_add_u32 s31, s31, 64
    v_mfma_f32_32x32x16_bf16 v[208:223], v[128:131], v[128:131], v[208:223]
    s_waitcnt lgkmcnt(0)
    s_waitcnt vmcnt(8)
    s_barrier
    v_mfma_f32_32x32x16_bf16 v[8:23], v[72:75], v[80:83], v[8:23]
    ds_read_b64_tr_b16 v[104:105], v184 offset:0
    ds_read_b64_tr_b16 v[106:107], v184 offset:1024
    v_mfma_f32_32x32x16_bf16 v[24:39], v[72:75], v[84:87], v[24:39]
    ds_read_b64_tr_b16 v[108:109], v185 offset:0
    ds_read_b64_tr_b16 v[110:111], v185 offset:1024
    v_mfma_f32_16x16x32_bf16 v[224:227], v[232:235], v[80:83], v[224:227]
    s_add_u32 m0, s34, 0
    s_nop 0
    buffer_load_dwordx4 v176, s[12:15], s28 offen lds
    v_mfma_f32_16x16x32_bf16 v[228:231], v[232:235], v[72:75], v[228:231]
    v_mfma_f32_32x32x16_bf16 v[40:55], v[76:79], v[80:83], v[40:55]
    ds_read_b128 v[112:115], v186 offset:0
    ds_read_b128 v[116:119], v188 offset:0
    v_mfma_f32_32x32x16_bf16 v[56:71], v[76:79], v[84:87], v[56:71]
    ds_read_b64_tr_b16 v[120:121], v184 offset:4096
    ds_read_b64_tr_b16 v[122:123], v184 offset:5120
    v_mfma_f32_32x32x16_bf16 v[208:223], v[80:83], v[80:83], v[208:223]
    ds_read_b64_tr_b16 v[124:125], v185 offset:4096
    ds_read_b64_tr_b16 v[126:127], v185 offset:5120
    s_add_u32 m0, s34, 1024
    s_add_u32 s28, s28, 114688
    buffer_load_dwordx4 v176, s[12:15], s29 offen lds
    v_mfma_f32_32x32x16_bf16 v[8:23], v[88:91], v[96:99], v[8:23]
    ds_read_b128 v[128:131], v187 offset:0
    ds_read_b128 v[132:135], v189 offset:0
    v_mfma_f32_32x32x16_bf16 v[24:39], v[88:91], v[100:103], v[24:39]
    v_mfma_f32_16x16x32_bf16 v[224:227], v[232:235], v[96:99], v[224:227]
    s_add_u32 m0, s34, 8192
    s_add_u32 s29, s29, 114688
    buffer_load_dwordx4 v177, s[16:19], s30 offen lds
    v_mfma_f32_16x16x32_bf16 v[228:231], v[232:235], v[88:91], v[228:231]
    v_mfma_f32_32x32x16_bf16 v[40:55], v[92:95], v[96:99], v[40:55]
    v_mfma_f32_32x32x16_bf16 v[56:71], v[92:95], v[100:103], v[56:71]
    s_add_u32 m0, s34, 9216
    s_add_u32 s30, s30, 64
    buffer_load_dwordx4 v177, s[16:19], s31 offen lds
    s_add_u32 s31, s31, 64
    v_mfma_f32_32x32x16_bf16 v[208:223], v[96:99], v[96:99], v[208:223]
    s_waitcnt lgkmcnt(0)
    s_waitcnt vmcnt(8)
    s_barrier
    v_mfma_f32_32x32x16_bf16 v[8:23], v[104:107], v[112:115], v[8:23]
    ds_read_b64_tr_b16 v[72:73], v184 offset:16384
    ds_read_b64_tr_b16 v[74:75], v184 offset:17408
    v_mfma_f32_32x32x16_bf16 v[24:39], v[104:107], v[116:119], v[24:39]
    ds_read_b64_tr_b16 v[76:77], v185 offset:16384
    ds_read_b64_tr_b16 v[78:79], v185 offset:17408
    v_mfma_f32_16x16x32_bf16 v[224:227], v[232:235], v[112:115], v[224:227]
    s_add_u32 m0, s34, 16384
    s_nop 0
    buffer_load_dwordx4 v176, s[12:15], s28 offen lds
    v_mfma_f32_16x16x32_bf16 v[228:231], v[232:235], v[104:107], v[228:231]
    v_mfma_f32_32x32x16_bf16 v[40:55], v[108:111], v[112:115], v[40:55]
    ds_read_b128 v[80:83], v186 offset:16384
    ds_read_b128 v[84:87], v188 offset:16384
    v_mfma_f32_32x32x16_bf16 v[56:71], v[108:111], v[116:119], v[56:71]
    ds_read_b64_tr_b16 v[88:89], v184 offset:20480
    ds_read_b64_tr_b16 v[90:91], v184 offset:21504
    v_mfma_f32_32x32x16_bf16 v[208:223], v[112:115], v[112:115], v[208:223]
    ds_read_b64_tr_b16 v[92:93], v185 offset:20480
    ds_read_b64_tr_b16 v[94:95], v185 offset:21504
    s_add_u32 m0, s34, 17408
    s_add_u32 s28, s28, 114688
    buffer_load_dwordx4 v176, s[12:15], s29 offen lds
    v_mfma_f32_32x32x16_bf16 v[8:23], v[120:123], v[128:131], v[8:23]
    ds_read_b128 v[96:99], v187 offset:16384
    ds_read_b128 v[100:103], v189 offset:16384
    v_mfma_f32_32x32x16_bf16 v[24:39], v[120:123], v[132:135], v[24:39]
    v_mfma_f32_16x16x32_bf16 v[224:227], v[232:235], v[128:131], v[224:227]
    s_add_u32 m0, s34, 24576
    s_add_u32 s29, s29, 114688
    buffer_load_dwordx4 v177, s[16:19], s30 offen lds
    v_mfma_f32_16x16x32_bf16 v[228:231], v[232:235], v[120:123], v[228:231]
    v_mfma_f32_32x32x16_bf16 v[40:55], v[124:127], v[128:131], v[40:55]
    v_mfma_f32_32x32x16_bf16 v[56:71], v[124:127], v[132:135], v[56:71]
    s_add_u32 m0, s34, 25600
    s_add_u32 s30, s30, 64
    buffer_load_dwordx4 v177, s[16:19], s31 offen lds
    s_add_u32 s31, s31, 64
    v_mfma_f32_32x32x16_bf16 v[208:223], v[128:131], v[128:131], v[208:223]
    s_waitcnt lgkmcnt(0)
    s_waitcnt vmcnt(8)
    s_barrier
    v_mfma_f32_32x32x16_bf16 v[8:23], v[72:75], v[80:83], v[8:23]
    ds_read_b64_tr_b16 v[104:105], v184 offset:32768
    ds_read_b64_tr_b16 v[106:107], v184 offset:33792
    v_mfma_f32_32x32x16_bf16 v[24:39], v[72:75], v[84:87], v[24:39]
    ds_read_b64_tr_b16 v[108:109], v185 offset:32768
    ds_read_b64_tr_b16 v[110:111], v185 offset:33792
    v_mfma_f32_16x16x32_bf16 v[224:227], v[232:235], v[80:83], v[224:227]
    s_add_u32 m0, s34, 32768
    s_nop 0
    buffer_load_dwordx4 v176, s[12:15], s28 offen lds
    v_mfma_f32_16x16x32_bf16 v[228:231], v[232:235], v[72:75], v[228:231]
    v_mfma_f32_32x32x16_bf16 v[40:55], v[76:79], v[80:83], v[40:55]
    ds_read_b128 v[112:115], v186 offset:32768
    ds_read_b128 v[116:119], v188 offset:32768
    v_mfma_f32_32x32x16_bf16 v[56:71], v[76:79], v[84:87], v[56:71]
    ds_read_b64_tr_b16 v[120:121], v184 offset:36864
    ds_read_b64_tr_b16 v[122:123], v184 offset:37888
    v_mfma_f32_32x32x16_bf16 v[208:223], v[80:83], v[80:83], v[208:223]
    ds_read_b64_tr_b16 v[124:125], v185 offset:36864
    ds_read_b64_tr_b16 v[126:127], v185 offset:37888
    s_add_u32 m0, s34, 33792
    s_add_u32 s28, s28, 114688
    buffer_load_dwordx4 v176, s[12:15], s29 offen lds
    v_mfma_f32_32x32x16_bf16 v[8:23], v[88:91], v[96:99], v[8:23]
    ds_read_b128 v[128:131], v187 offset:32768
    ds_read_b128 v[132:135], v189 offset:32768
    v_mfma_f32_32x32x16_bf16 v[24:39], v[88:91], v[100:103], v[24:39]
    v_mfma_f32_16x16x32_bf16 v[224:227], v[232:235], v[96:99], v[224:227]
    s_add_u32 m0, s34, 40960
    s_add_u32 s29, s29, 114688
    buffer_load_dwordx4 v177, s[16:19], s30 offen lds
    v_mfma_f32_16x16x32_bf16 v[228:231], v[232:235], v[88:91], v[228:231]
    v_mfma_f32_32x32x16_bf16 v[40:55], v[92:95], v[96:99], v[40:55]
    v_mfma_f32_32x32x16_bf16 v[56:71], v[92:95], v[100:103], v[56:71]
    s_add_u32 m0, s34, 41984
    s_add_u32 s30, s30, 64
    buffer_load_dwordx4 v177, s[16:19], s31 offen lds
    s_add_u32 s31, s31, 64
    v_mfma_f32_32x32x16_bf16 v[208:223], v[96:99], v[96:99], v[208:223]
    s_waitcnt lgkmcnt(0)
    s_waitcnt vmcnt(8)
    s_barrier
    v_mfma_f32_32x32x16_bf16 v[8:23], v[104:107], v[112:115], v[8:23]
    ds_read_b64_tr_b16 v[72:73], v178 offset:0
    ds_read_b64_tr_b16 v[74:75], v178 offset:1024
    v_mfma_f32_32x32x16_bf16 v[24:39], v[104:107], v[116:119], v[24:39]
    ds_read_b64_tr_b16 v[76:77], v179 offset:0
    ds_read_b64_tr_b16 v[78:79], v179 offset:1024
    v_mfma_f32_16x16x32_bf16 v[224:227], v[232:235], v[112:115], v[224:227]
    s_add_u32 m0, s34, 49152
    s_nop 0
    buffer_load_dwordx4 v176, s[12:15], s28 offen lds
    v_mfma_f32_16x16x32_bf16 v[228:231], v[232:235], v[104:107], v[228:231]
    v_mfma_f32_32x32x16_bf16 v[40:55], v[108:111], v[112:115], v[40:55]
    ds_read_b128 v[80:83], v180 offset:0
    ds_read_b128 v[84:87], v182 offset:0
    v_mfma_f32_32x32x16_bf16 v[56:71], v[108:111], v[116:119], v[56:71]
    ds_read_b64_tr_b16 v[88:89], v178 offset:4096
    ds_read_b64_tr_b16 v[90:91], v178 offset:5120
    v_mfma_f32_32x32x16_bf16 v[208:223], v[112:115], v[112:115], v[208:223]
    ds_read_b64_tr_b16 v[92:93], v179 offset:4096
    ds_read_b64_tr_b16 v[94:95], v179 offset:5120
    s_add_u32 m0, s34, 50176
    s_add_u32 s28, s28, 114688
    buffer_load_dwordx4 v176, s[12:15], s29 offen lds
    v_mfma_f32_32x32x16_bf16 v[8:23], v[120:123], v[128:131], v[8:23]
    ds_read_b128 v[96:99], v181 offset:0
    ds_read_b128 v[100:103], v183 offset:0
    v_mfma_f32_32x32x16_bf16 v[24:39], v[120:123], v[132:135], v[24:39]
    v_mfma_f32_16x16x32_bf16 v[224:227], v[232:235], v[128:131], v[224:227]
    s_add_u32 m0, s34, 57344
    s_add_u32 s29, s29, 114688
    buffer_load_dwordx4 v177, s[16:19], s30 offen lds
    v_mfma_f32_16x16x32_bf16 v[228:231], v[232:235], v[120:123], v[228:231]
    v_mfma_f32_32x32x16_bf16 v[40:55], v[124:127], v[128:131], v[40:55]
    v_mfma_f32_32x32x16_bf16 v[56:71], v[124:127], v[132:135], v[56:71]
    s_add_u32 m0, s34, 58368
    s_add_u32 s30, s30, 64
    buffer_load_dwordx4 v177, s[16:19], s31 offen lds
    s_add_u32 s31, s31, 64
    v_mfma_f32_32x32x16_bf16 v[208:223], v[128:131], v[128:131], v[208:223]
    buffer_load_dwordx2 v[160:161], v190, s[24:27], s37 offen offset:0
    buffer_load_dwordx2 v[162:163], v190, s[24:27], s37 offen offset:16
    buffer_load_dwordx2 v[164:165], v190, s[24:27], s37 offen offset:32
    buffer_load_dwordx2 v[166:167], v190, s[24:27], s37 offen offset:48
    buffer_load_dwordx2 v[168:169], v190, s[24:27], s38 offen offset:0
    buffer_load_dwordx2 v[170:171], v190, s[24:27], s38 offen offset:16
    buffer_load_dwordx2 v[172:173], v190, s[24:27], s38 offen offset:32
    buffer_load_dwordx2 v[174:175], v190, s[24:27], s38 offen offset:48
    s_waitcnt lgkmcnt(0)
    s_waitcnt vmcnt(16)
    s_barrier
    v_mfma_f32_32x32x16_bf16 v[8:23], v[72:75], v[80:83], v[8:23]
    ds_read_b64_tr_b16 v[104:105], v178 offset:16384
    ds_read_b64_tr_b16 v[106:107], v178 offset:17408
    v_mfma_f32_32x32x16_bf16 v[24:39], v[72:75], v[84:87], v[24:39]
    ds_read_b64_tr_b16 v[108:109], v179 offset:16384
    ds_read_b64_tr_b16 v[110:111], v179 offset:17408
    v_mfma_f32_16x16x32_bf16 v[224:227], v[232:235], v[80:83], v[224:227]
    v_mfma_f32_16x16x32_bf16 v[228:231], v[232:235], v[72:75], v[228:231]
    v_mfma_f32_32x32x16_bf16 v[40:55], v[76:79], v[80:83], v[40:55]
    ds_read_b128 v[112:115], v180 offset:16384
    ds_read_b128 v[116:119], v182 offset:16384
    v_mfma_f32_32x32x16_bf16 v[56:71], v[76:79], v[84:87], v[56:71]
    ds_read_b64_tr_b16 v[120:121], v178 offset:20480
    ds_read_b64_tr_b16 v[122:123], v178 offset:21504
    v_mfma_f32_32x32x16_bf16 v[208:223], v[80:83], v[80:83], v[208:223]
    ds_read_b64_tr_b16 v[124:125], v179 offset:20480
    ds_read_b64_tr_b16 v[126:127], v179 offset:21504
    v_mfma_f32_32x32x16_bf16 v[8:23], v[88:91], v[96:99], v[8:23]
    ds_read_b128 v[128:131], v181 offset:16384
    ds_read_b128 v[132:135], v183 offset:16384
    v_mfma_f32_32x32x16_bf16 v[24:39], v[88:91], v[100:103], v[24:39]
    v_mfma_f32_16x16x32_bf16 v[224:227], v[232:235], v[96:99], v[224:227]
    v_mfma_f32_16x16x32_bf16 v[228:231], v[232:235], v[88:91], v[228:231]
    v_mfma_f32_32x32x16_bf16 v[40:55], v[92:95], v[96:99], v[40:55]
    v_mfma_f32_32x32x16_bf16 v[56:71], v[92:95], v[100:103], v[56:71]
    v_mfma_f32_32x32x16_bf16 v[208:223], v[96:99], v[96:99], v[208:223]
    s_waitcnt lgkmcnt(0)
    s_waitcnt vmcnt(12)
    s_barrier
    v_mfma_f32_32x32x16_bf16 v[8:23], v[104:107], v[112:115], v[8:23]
    ds_read_b64_tr_b16 v[72:73], v184 offset:0
    ds_read_b64_tr_b16 v[74:75], v184 offset:1024
    v_mfma_f32_32x32x16_bf16 v[24:39], v[104:107], v[116:119], v[24:39]
    ds_read_b64_tr_b16 v[76:77], v185 offset:0
    ds_read_b64_tr_b16 v[78:79], v185 offset:1024
    v_mfma_f32_16x16x32_bf16 v[224:227], v[232:235], v[112:115], v[224:227]
    v_mfma_f32_16x16x32_bf16 v[228:231], v[232:235], v[104:107], v[228:231]
    v_mfma_f32_32x32x16_bf16 v[40:55], v[108:111], v[112:115], v[40:55]
    ds_read_b128 v[80:83], v186 offset:0
    ds_read_b128 v[84:87], v188 offset:0
    v_mfma_f32_32x32x16_bf16 v[56:71], v[108:111], v[116:119], v[56:71]
    ds_read_b64_tr_b16 v[88:89], v184 offset:4096
    ds_read_b64_tr_b16 v[90:91], v184 offset:5120
    v_mfma_f32_32x32x16_bf16 v[208:223], v[112:115], v[112:115], v[208:223]
    ds_read_b64_tr_b16 v[92:93], v185 offset:4096
    ds_read_b64_tr_b16 v[94:95], v185 offset:5120
    v_mfma_f32_32x32x16_bf16 v[8:23], v[120:123], v[128:131], v[8:23]
    ds_read_b128 v[96:99], v187 offset:0
    ds_read_b128 v[100:103], v189 offset:0
    v_mfma_f32_32x32x16_bf16 v[24:39], v[120:123], v[132:135], v[24:39]
    v_mfma_f32_16x16x32_bf16 v[224:227], v[232:235], v[128:131], v[224:227]
    v_mfma_f32_16x16x32_bf16 v[228:231], v[232:235], v[120:123], v[228:231]
    v_mfma_f32_32x32x16_bf16 v[40:55], v[124:127], v[128:131], v[40:55]
    v_mfma_f32_32x32x16_bf16 v[56:71], v[124:127], v[132:135], v[56:71]
    v_mfma_f32_32x32x16_bf16 v[208:223], v[128:131], v[128:131], v[208:223]
    s_waitcnt lgkmcnt(0)
    s_waitcnt vmcnt(8)
    s_barrier
    v_mfma_f32_32x32x16_bf16 v[8:23], v[72:75], v[80:83], v[8:23]
    ds_read_b64_tr_b16 v[104:105], v184 offset:16384
    ds_read_b64_tr_b16 v[106:107], v184 offset:17408
    v_mfma_f32_32x32x16_bf16 v[24:39], v[72:75], v[84:87], v[24:39]
    ds_read_b64_tr_b16 v[108:109], v185 offset:16384
    ds_read_b64_tr_b16 v[110:111], v185 offset:17408
    v_mfma_f32_16x16x32_bf16 v[224:227], v[232:235], v[80:83], v[224:227]
    v_mfma_f32_16x16x32_bf16 v[228:231], v[232:235], v[72:75], v[228:231]
    v_mfma_f32_32x32x16_bf16 v[40:55], v[76:79], v[80:83], v[40:55]
    ds_read_b128 v[112:115], v186 offset:16384
    ds_read_b128 v[116:119], v188 offset:16384
    v_mfma_f32_32x32x16_bf16 v[56:71], v[76:79], v[84:87], v[56:71]
    ds_read_b64_tr_b16 v[120:121], v184 offset:20480
    ds_read_b64_tr_b16 v[122:123], v184 offset:21504
    v_mfma_f32_32x32x16_bf16 v[208:223], v[80:83], v[80:83], v[208:223]
    ds_read_b64_tr_b16 v[124:125], v185 offset:20480
    ds_read_b64_tr_b16 v[126:127], v185 offset:21504
    v_mfma_f32_32x32x16_bf16 v[8:23], v[88:91], v[96:99], v[8:23]
    ds_read_b128 v[128:131], v187 offset:16384
    ds_read_b128 v[132:135], v189 offset:16384
    v_mfma_f32_32x32x16_bf16 v[24:39], v[88:91], v[100:103], v[24:39]
    v_mfma_f32_16x16x32_bf16 v[224:227], v[232:235], v[96:99], v[224:227]
    v_mfma_f32_16x16x32_bf16 v[228:231], v[232:235], v[88:91], v[228:231]
    v_mfma_f32_32x32x16_bf16 v[40:55], v[92:95], v[96:99], v[40:55]
    v_mfma_f32_32x32x16_bf16 v[56:71], v[92:95], v[100:103], v[56:71]
    v_mfma_f32_32x32x16_bf16 v[208:223], v[96:99], v[96:99], v[208:223]
    s_waitcnt lgkmcnt(0)
    v_mfma_f32_32x32x16_bf16 v[8:23], v[104:107], v[112:115], v[8:23]
    v_mfma_f32_32x32x16_bf16 v[24:39], v[104:107], v[116:119], v[24:39]
    v_mfma_f32_16x16x32_bf16 v[224:227], v[232:235], v[112:115], v[224:227]
    v_mfma_f32_16x16x32_bf16 v[228:231], v[232:235], v[104:107], v[228:231]
    v_mfma_f32_32x32x16_bf16 v[40:55], v[108:111], v[112:115], v[40:55]
    v_mfma_f32_32x32x16_bf16 v[56:71], v[108:111], v[116:119], v[56:71]
    v_mfma_f32_32x32x16_bf16 v[208:223], v[112:115], v[112:115], v[208:223]
    v_mfma_f32_32x32x16_bf16 v[8:23], v[120:123], v[128:131], v[8:23]
    v_mfma_f32_32x32x16_bf16 v[24:39], v[120:123], v[132:135], v[24:39]
    v_mfma_f32_16x16x32_bf16 v[224:227], v[232:235], v[128:131], v[224:227]
    v_mfma_f32_16x16x32_bf16 v[228:231], v[232:235], v[120:123], v[228:231]
    v_mfma_f32_32x32x16_bf16 v[40:55], v[124:127], v[128:131], v[40:55]
    v_mfma_f32_32x32x16_bf16 v[56:71], v[124:127], v[132:135], v[56:71]
    v_mfma_f32_32x32x16_bf16 v[208:223], v[128:131], v[128:131], v[208:223]
    v_and_b32 v5, 31, v1
    v_lshrrev_b32 v6, 3, v5
    v_and_b32 v204, 3, v5
    v_lshl_add_u32 v6, v6, 2, v204
    s_nop 7
    s_nop 7
    v_mov_b32 v192, v208

    v_cmp_eq_u32 vcc, 1, v6
    s_nop 0
    v_cndmask_b32 v192, v192, v209, vcc
    v_cmp_eq_u32 vcc, 2, v6
    s_nop 0
    v_cndmask_b32 v192, v192, v210, vcc
    v_cmp_eq_u32 vcc, 3, v6
    s_nop 0
    v_cndmask_b32 v192, v192, v211, vcc
    v_cmp_eq_u32 vcc, 4, v6
    s_nop 0
    v_cndmask_b32 v192, v192, v212, vcc
    v_cmp_eq_u32 vcc, 5, v6
    s_nop 0
    v_cndmask_b32 v192, v192, v213, vcc
    v_cmp_eq_u32 vcc, 6, v6
    s_nop 0
    v_cndmask_b32 v192, v192, v214, vcc
    v_cmp_eq_u32 vcc, 7, v6
    s_nop 0
    v_cndmask_b32 v192, v192, v215, vcc
    v_cmp_eq_u32 vcc, 8, v6
    s_nop 0
    v_cndmask_b32 v192, v192, v216, vcc
    v_cmp_eq_u32 vcc, 9, v6
    s_nop 0
    v_cndmask_b32 v192, v192, v217, vcc
    v_cmp_eq_u32 vcc, 10, v6
    s_nop 0
    v_cndmask_b32 v192, v192, v218, vcc
    v_cmp_eq_u32 vcc, 11, v6
    s_nop 0
    v_cndmask_b32 v192, v192, v219, vcc
    v_cmp_eq_u32 vcc, 12, v6
    s_nop 0
    v_cndmask_b32 v192, v192, v220, vcc
    v_cmp_eq_u32 vcc, 13, v6
    s_nop 0
    v_cndmask_b32 v192, v192, v221, vcc
    v_cmp_eq_u32 vcc, 14, v6
    s_nop 0
    v_cndmask_b32 v192, v192, v222, vcc
    v_cmp_eq_u32 vcc, 15, v6
    s_nop 0
    v_cndmask_b32 v192, v192, v223, vcc
    s_lshl_b32 s47, s42, 8
    s_add_u32 s47, s47, 0
    v_lshl_add_u32 v205, v5, 3, s47
    v_lshrrev_b32 v6, 2, v5
    v_and_b32 v6, 1, v6
    v_cmp_eq_u32 vcc, v6, v7
    s_and_saveexec_b64 s[58:59], vcc
    ds_write_b32 v205, v192 offset:4
    s_mov_b64 exec, s[58:59]
    v_cmp_gt_u32 vcc, 16, v1
    v_lshl_add_u32 v205, v1, 3, s47
    s_lshl_b32 s47, s40, 7
    s_add_u32 s47, s47, 1024
    v_lshl_add_u32 v206, v1, 2, s47
    s_and_saveexec_b64 s[58:59], vcc
    ds_write_b32 v205, v224
    ds_write_b32 v205, v225 offset:128
    ds_write_b32 v206, v228
    ds_write_b32 v206, v229 offset:64
    s_mov_b64 exec, s[58:59]
    s_lshl_b32 s47, s42, 8
    s_add_u32 s47, s47, 0
    v_lshl_add_u32 v207, v5, 3, s47
    s_lshl_b32 s47, s43, 8
    s_add_u32 s47, s47, 0
    v_lshl_add_u32 v6, v5, 3, s47
    v_lshlrev_b32 v204, 4, v7
    s_lshl_b32 s47, s40, 7
    s_add_u32 s47, s47, 1024
    v_add_u32 v205, s47, v204
    s_lshl_b32 s47, s41, 7
    s_add_u32 s47, s47, 1024
    v_add_u32 v206, s47, v204
    s_waitcnt lgkmcnt(0)
    s_barrier
    ds_read_b64 v[192:193], v207
    ds_read_b64 v[194:195], v6

    ds_read_b128 v[72:75], v205 offset:0
    ds_read_b128 v[76:79], v205 offset:32
    ds_read_b128 v[80:83], v205 offset:64
    ds_read_b128 v[84:87], v205 offset:96
    ds_read_b128 v[88:91], v206 offset:0
    ds_read_b128 v[92:95], v206 offset:32
    ds_read_b128 v[96:99], v206 offset:64
    ds_read_b128 v[100:103], v206 offset:96
    s_waitcnt vmcnt(0)
    v_lshlrev_b32 v104, 16, v160
    v_and_b32 v105, 0xffff0000, v160
    v_lshlrev_b32 v106, 16, v161
    v_and_b32 v107, 0xffff0000, v161
    v_lshlrev_b32 v108, 16, v162
    v_and_b32 v109, 0xffff0000, v162
    v_lshlrev_b32 v110, 16, v163
    v_and_b32 v111, 0xffff0000, v163
    v_lshlrev_b32 v112, 16, v164
    v_and_b32 v113, 0xffff0000, v164
    v_lshlrev_b32 v114, 16, v165
    v_and_b32 v115, 0xffff0000, v165
    v_lshlrev_b32 v116, 16, v166
    v_and_b32 v117, 0xffff0000, v166
    v_lshlrev_b32 v118, 16, v167
    v_and_b32 v119, 0xffff0000, v167
    v_lshlrev_b32 v120, 16, v168
    v_and_b32 v121, 0xffff0000, v168
    v_lshlrev_b32 v122, 16, v169
    v_and_b32 v123, 0xffff0000, v169
    v_lshlrev_b32 v124, 16, v170
    v_and_b32 v125, 0xffff0000, v170
    v_lshlrev_b32 v126, 16, v171
    v_and_b32 v127, 0xffff0000, v171
    v_lshlrev_b32 v128, 16, v172
    v_and_b32 v129, 0xffff0000, v172
    v_lshlrev_b32 v130, 16, v173
    v_and_b32 v131, 0xffff0000, v173
    v_lshlrev_b32 v132, 16, v174
    v_and_b32 v133, 0xffff0000, v174
    v_lshlrev_b32 v134, 16, v175
    v_and_b32 v135, 0xffff0000, v175
    s_waitcnt lgkmcnt(8)
    s_mov_b32 s47, 0x3b124925
    v_mul_f32 v192, s47, v192
    v_mul_f32 v193, s47, v193
    v_fma_f32 v193, -v192, v192, v193
    v_max_f32 v193, 0, v193
    v_cvt_pk_bf16_f32 v5, v192, v193
    v_and_b32 v6, 0xffff0000, v5
    v_lshlrev_b32 v5, 16, v5
    v_add_f32 v6, 0x3727c5ac, v6
    v_cvt_pk_bf16_f32 v6, v6, v6
    v_and_b32 v6, 0xffff0000, v6
    v_sqrt_f32 v6, v6
    s_nop 0
    v_cvt_pk_bf16_f32 v6, v6, v6
    v_and_b32 v6, 0xffff0000, v6
    v_rcp_f32 v200, v6
    s_nop 0
    v_mul_f32 v201, v5, v200

    v_mul_f32 v194, s47, v194
    v_mul_f32 v195, s47, v195
    v_fma_f32 v195, -v194, v194, v195
    v_max_f32 v195, 0, v195
    v_cvt_pk_bf16_f32 v5, v194, v195
    v_and_b32 v6, 0xffff0000, v5
    v_lshlrev_b32 v5, 16, v5
    v_add_f32 v6, 0x3727c5ac, v6
    v_cvt_pk_bf16_f32 v6, v6, v6
    v_and_b32 v6, 0xffff0000, v6
    v_sqrt_f32 v6, v6
    s_nop 0
    v_cvt_pk_bf16_f32 v6, v6, v6
    v_and_b32 v6, 0xffff0000, v6
    v_rcp_f32 v202, v6
    s_nop 0
    v_mul_f32 v203, v5, v202

    s_lshl_b32 s47, s9, 2
    s_add_u32 s48, s47, s42
    s_add_u32 s49, s47, s43
    s_mul_i32 s48, s48, 112
    s_mul_i32 s49, s49, 112
    s_lshl_b32 s47, s10, 3
    s_add_u32 s48, s48, s47
    s_add_u32 s49, s49, s47
    s_lshl_b32 s40, s40, 1
    s_lshl_b32 s41, s41, 1
    s_add_u32 s54, s48, s40
    s_add_u32 s55, s48, s41
    s_add_u32 s56, s49, s40
    s_add_u32 s57, s49, s41
    s_lshl_b32 s54, s54, 10
    s_lshl_b32 s55, s55, 10
    s_lshl_b32 s56, s56, 10
    s_lshl_b32 s57, s57, 10
    v_lshlrev_b32 v3, 4, v1
    s_waitcnt lgkmcnt(0)

    v_pk_fma_f32 v[136:137], v[72:73], v[200:201], v[104:105] op_sel:[0,1,0] op_sel_hi:[1,1,1] neg_lo:[1,0,0] neg_hi:[1,0,0]
    v_pk_fma_f32 v[138:139], v[74:75], v[200:201], v[106:107] op_sel:[0,1,0] op_sel_hi:[1,1,1] neg_lo:[1,0,0] neg_hi:[1,0,0]
    v_pk_fma_f32 v[140:141], v[76:77], v[200:201], v[108:109] op_sel:[0,1,0] op_sel_hi:[1,1,1] neg_lo:[1,0,0] neg_hi:[1,0,0]
    v_pk_fma_f32 v[142:143], v[78:79], v[200:201], v[110:111] op_sel:[0,1,0] op_sel_hi:[1,1,1] neg_lo:[1,0,0] neg_hi:[1,0,0]
    v_pk_fma_f32 v[8:9], v[8:9], v[200:201], v[136:137] op_sel:[0,0,0] op_sel_hi:[1,0,1]
    v_pk_fma_f32 v[10:11], v[10:11], v[200:201], v[138:139] op_sel:[0,0,0] op_sel_hi:[1,0,1]
    v_pk_fma_f32 v[12:13], v[12:13], v[200:201], v[140:141] op_sel:[0,0,0] op_sel_hi:[1,0,1]
    v_pk_fma_f32 v[14:15], v[14:15], v[200:201], v[142:143] op_sel:[0,0,0] op_sel_hi:[1,0,1]
    v_pk_mul_f32 v[136:137], v[8:9], s[44:45]
    v_pk_mul_f32 v[138:139], v[10:11], s[44:45]
    v_pk_mul_f32 v[140:141], v[12:13], s[44:45]
    v_pk_mul_f32 v[142:143], v[14:15], s[44:45]
    v_exp_f32 v136, v136
    v_exp_f32 v137, v137
    v_exp_f32 v138, v138
    v_exp_f32 v139, v139
    v_exp_f32 v140, v140
    v_exp_f32 v141, v141
    v_exp_f32 v142, v142
    v_exp_f32 v143, v143
    v_pk_add_f32 v[144:145], v[136:137], 2.0 op_sel_hi:[1,0]
    v_pk_add_f32 v[146:147], v[138:139], 2.0 op_sel_hi:[1,0]
    v_pk_add_f32 v[148:149], v[140:141], 2.0 op_sel_hi:[1,0]
    v_pk_add_f32 v[150:151], v[142:143], 2.0 op_sel_hi:[1,0]
    v_pk_fma_f32 v[136:137], v[136:137], v[144:145], 2.0 op_sel_hi:[1,1,0]
    v_pk_fma_f32 v[138:139], v[138:139], v[146:147], 2.0 op_sel_hi:[1,1,0]
    v_pk_fma_f32 v[140:141], v[140:141], v[148:149], 2.0 op_sel_hi:[1,1,0]
    v_pk_fma_f32 v[142:143], v[142:143], v[150:151], 2.0 op_sel_hi:[1,1,0]
    v_rcp_f32 v136, v136
    v_rcp_f32 v137, v137
    v_rcp_f32 v138, v138
    v_rcp_f32 v139, v139
    v_rcp_f32 v140, v140
    v_rcp_f32 v141, v141
    v_rcp_f32 v142, v142
    v_rcp_f32 v143, v143
    v_pk_fma_f32 v[136:137], v[136:137], -2.0, 1.0 op_sel_hi:[1,0,0]
    v_pk_fma_f32 v[138:139], v[138:139], -2.0, 1.0 op_sel_hi:[1,0,0]
    v_pk_fma_f32 v[140:141], v[140:141], -2.0, 1.0 op_sel_hi:[1,0,0]
    v_pk_fma_f32 v[142:143], v[142:143], -2.0, 1.0 op_sel_hi:[1,0,0]
    v_pk_mul_f32 v[8:9], v[8:9], v[136:137]
    v_pk_mul_f32 v[10:11], v[10:11], v[138:139]
    v_pk_mul_f32 v[12:13], v[12:13], v[140:141]
    v_pk_mul_f32 v[14:15], v[14:15], v[142:143]
    v_cvt_pk_bf16_f32 v152, v8, v9
    v_cvt_pk_bf16_f32 v153, v10, v11
    v_cvt_pk_bf16_f32 v154, v12, v13
    v_cvt_pk_bf16_f32 v155, v14, v15
    buffer_store_dwordx4 v[152:155], v3, s[20:23], s54 offen offset:0 sc1
    v_pk_fma_f32 v[136:137], v[80:81], v[200:201], v[112:113] op_sel:[0,1,0] op_sel_hi:[1,1,1] neg_lo:[1,0,0] neg_hi:[1,0,0]
    v_pk_fma_f32 v[138:139], v[82:83], v[200:201], v[114:115] op_sel:[0,1,0] op_sel_hi:[1,1,1] neg_lo:[1,0,0] neg_hi:[1,0,0]
    v_pk_fma_f32 v[140:141], v[84:85], v[200:201], v[116:117] op_sel:[0,1,0] op_sel_hi:[1,1,1] neg_lo:[1,0,0] neg_hi:[1,0,0]
    v_pk_fma_f32 v[142:143], v[86:87], v[200:201], v[118:119] op_sel:[0,1,0] op_sel_hi:[1,1,1] neg_lo:[1,0,0] neg_hi:[1,0,0]
    v_pk_fma_f32 v[16:17], v[16:17], v[200:201], v[136:137] op_sel:[0,0,0] op_sel_hi:[1,0,1]
    v_pk_fma_f32 v[18:19], v[18:19], v[200:201], v[138:139] op_sel:[0,0,0] op_sel_hi:[1,0,1]
    v_pk_fma_f32 v[20:21], v[20:21], v[200:201], v[140:141] op_sel:[0,0,0] op_sel_hi:[1,0,1]
    v_pk_fma_f32 v[22:23], v[22:23], v[200:201], v[142:143] op_sel:[0,0,0] op_sel_hi:[1,0,1]
    v_pk_mul_f32 v[136:137], v[16:17], s[44:45]
    v_pk_mul_f32 v[138:139], v[18:19], s[44:45]
    v_pk_mul_f32 v[140:141], v[20:21], s[44:45]
    v_pk_mul_f32 v[142:143], v[22:23], s[44:45]
    v_exp_f32 v136, v136
    v_exp_f32 v137, v137
    v_exp_f32 v138, v138
    v_exp_f32 v139, v139
    v_exp_f32 v140, v140
    v_exp_f32 v141, v141
    v_exp_f32 v142, v142
    v_exp_f32 v143, v143
    v_pk_add_f32 v[144:145], v[136:137], 2.0 op_sel_hi:[1,0]
    v_pk_add_f32 v[146:147], v[138:139], 2.0 op_sel_hi:[1,0]
    v_pk_add_f32 v[148:149], v[140:141], 2.0 op_sel_hi:[1,0]
    v_pk_add_f32 v[150:151], v[142:143], 2.0 op_sel_hi:[1,0]
    v_pk_fma_f32 v[136:137], v[136:137], v[144:145], 2.0 op_sel_hi:[1,1,0]
    v_pk_fma_f32 v[138:139], v[138:139], v[146:147], 2.0 op_sel_hi:[1,1,0]
    v_pk_fma_f32 v[140:141], v[140:141], v[148:149], 2.0 op_sel_hi:[1,1,0]
    v_pk_fma_f32 v[142:143], v[142:143], v[150:151], 2.0 op_sel_hi:[1,1,0]
    v_rcp_f32 v136, v136
    v_rcp_f32 v137, v137
    v_rcp_f32 v138, v138
    v_rcp_f32 v139, v139
    v_rcp_f32 v140, v140
    v_rcp_f32 v141, v141
    v_rcp_f32 v142, v142
    v_rcp_f32 v143, v143
    v_pk_fma_f32 v[136:137], v[136:137], -2.0, 1.0 op_sel_hi:[1,0,0]
    v_pk_fma_f32 v[138:139], v[138:139], -2.0, 1.0 op_sel_hi:[1,0,0]
    v_pk_fma_f32 v[140:141], v[140:141], -2.0, 1.0 op_sel_hi:[1,0,0]
    v_pk_fma_f32 v[142:143], v[142:143], -2.0, 1.0 op_sel_hi:[1,0,0]
    v_pk_mul_f32 v[16:17], v[16:17], v[136:137]
    v_pk_mul_f32 v[18:19], v[18:19], v[138:139]
    v_pk_mul_f32 v[20:21], v[20:21], v[140:141]
    v_pk_mul_f32 v[22:23], v[22:23], v[142:143]
    v_cvt_pk_bf16_f32 v156, v16, v17
    v_cvt_pk_bf16_f32 v157, v18, v19
    v_cvt_pk_bf16_f32 v158, v20, v21
    v_cvt_pk_bf16_f32 v159, v22, v23
    buffer_store_dwordx4 v[156:159], v3, s[20:23], s54 offen offset:1024 sc1
    v_pk_fma_f32 v[136:137], v[88:89], v[200:201], v[120:121] op_sel:[0,1,0] op_sel_hi:[1,1,1] neg_lo:[1,0,0] neg_hi:[1,0,0]
    v_pk_fma_f32 v[138:139], v[90:91], v[200:201], v[122:123] op_sel:[0,1,0] op_sel_hi:[1,1,1] neg_lo:[1,0,0] neg_hi:[1,0,0]
    v_pk_fma_f32 v[140:141], v[92:93], v[200:201], v[124:125] op_sel:[0,1,0] op_sel_hi:[1,1,1] neg_lo:[1,0,0] neg_hi:[1,0,0]
    v_pk_fma_f32 v[142:143], v[94:95], v[200:201], v[126:127] op_sel:[0,1,0] op_sel_hi:[1,1,1] neg_lo:[1,0,0] neg_hi:[1,0,0]
    v_pk_fma_f32 v[40:41], v[40:41], v[200:201], v[136:137] op_sel:[0,0,0] op_sel_hi:[1,0,1]
    v_pk_fma_f32 v[42:43], v[42:43], v[200:201], v[138:139] op_sel:[0,0,0] op_sel_hi:[1,0,1]
    v_pk_fma_f32 v[44:45], v[44:45], v[200:201], v[140:141] op_sel:[0,0,0] op_sel_hi:[1,0,1]
    v_pk_fma_f32 v[46:47], v[46:47], v[200:201], v[142:143] op_sel:[0,0,0] op_sel_hi:[1,0,1]
    v_pk_mul_f32 v[136:137], v[40:41], s[44:45]
    v_pk_mul_f32 v[138:139], v[42:43], s[44:45]
    v_pk_mul_f32 v[140:141], v[44:45], s[44:45]
    v_pk_mul_f32 v[142:143], v[46:47], s[44:45]
    v_exp_f32 v136, v136
    v_exp_f32 v137, v137
    v_exp_f32 v138, v138
    v_exp_f32 v139, v139
    v_exp_f32 v140, v140
    v_exp_f32 v141, v141
    v_exp_f32 v142, v142
    v_exp_f32 v143, v143
    v_pk_add_f32 v[144:145], v[136:137], 2.0 op_sel_hi:[1,0]
    v_pk_add_f32 v[146:147], v[138:139], 2.0 op_sel_hi:[1,0]
    v_pk_add_f32 v[148:149], v[140:141], 2.0 op_sel_hi:[1,0]
    v_pk_add_f32 v[150:151], v[142:143], 2.0 op_sel_hi:[1,0]
    v_pk_fma_f32 v[136:137], v[136:137], v[144:145], 2.0 op_sel_hi:[1,1,0]
    v_pk_fma_f32 v[138:139], v[138:139], v[146:147], 2.0 op_sel_hi:[1,1,0]
    v_pk_fma_f32 v[140:141], v[140:141], v[148:149], 2.0 op_sel_hi:[1,1,0]
    v_pk_fma_f32 v[142:143], v[142:143], v[150:151], 2.0 op_sel_hi:[1,1,0]
    v_rcp_f32 v136, v136
    v_rcp_f32 v137, v137
    v_rcp_f32 v138, v138
    v_rcp_f32 v139, v139
    v_rcp_f32 v140, v140
    v_rcp_f32 v141, v141
    v_rcp_f32 v142, v142
    v_rcp_f32 v143, v143
    v_pk_fma_f32 v[136:137], v[136:137], -2.0, 1.0 op_sel_hi:[1,0,0]
    v_pk_fma_f32 v[138:139], v[138:139], -2.0, 1.0 op_sel_hi:[1,0,0]
    v_pk_fma_f32 v[140:141], v[140:141], -2.0, 1.0 op_sel_hi:[1,0,0]
    v_pk_fma_f32 v[142:143], v[142:143], -2.0, 1.0 op_sel_hi:[1,0,0]
    v_pk_mul_f32 v[40:41], v[40:41], v[136:137]
    v_pk_mul_f32 v[42:43], v[42:43], v[138:139]
    v_pk_mul_f32 v[44:45], v[44:45], v[140:141]
    v_pk_mul_f32 v[46:47], v[46:47], v[142:143]
    v_cvt_pk_bf16_f32 v152, v40, v41
    v_cvt_pk_bf16_f32 v153, v42, v43
    v_cvt_pk_bf16_f32 v154, v44, v45
    v_cvt_pk_bf16_f32 v155, v46, v47
    buffer_store_dwordx4 v[152:155], v3, s[20:23], s55 offen offset:0 sc1
    v_pk_fma_f32 v[136:137], v[96:97], v[200:201], v[128:129] op_sel:[0,1,0] op_sel_hi:[1,1,1] neg_lo:[1,0,0] neg_hi:[1,0,0]
    v_pk_fma_f32 v[138:139], v[98:99], v[200:201], v[130:131] op_sel:[0,1,0] op_sel_hi:[1,1,1] neg_lo:[1,0,0] neg_hi:[1,0,0]
    v_pk_fma_f32 v[140:141], v[100:101], v[200:201], v[132:133] op_sel:[0,1,0] op_sel_hi:[1,1,1] neg_lo:[1,0,0] neg_hi:[1,0,0]
    v_pk_fma_f32 v[142:143], v[102:103], v[200:201], v[134:135] op_sel:[0,1,0] op_sel_hi:[1,1,1] neg_lo:[1,0,0] neg_hi:[1,0,0]
    v_pk_fma_f32 v[48:49], v[48:49], v[200:201], v[136:137] op_sel:[0,0,0] op_sel_hi:[1,0,1]
    v_pk_fma_f32 v[50:51], v[50:51], v[200:201], v[138:139] op_sel:[0,0,0] op_sel_hi:[1,0,1]
    v_pk_fma_f32 v[52:53], v[52:53], v[200:201], v[140:141] op_sel:[0,0,0] op_sel_hi:[1,0,1]
    v_pk_fma_f32 v[54:55], v[54:55], v[200:201], v[142:143] op_sel:[0,0,0] op_sel_hi:[1,0,1]
    v_pk_mul_f32 v[136:137], v[48:49], s[44:45]
    v_pk_mul_f32 v[138:139], v[50:51], s[44:45]
    v_pk_mul_f32 v[140:141], v[52:53], s[44:45]
    v_pk_mul_f32 v[142:143], v[54:55], s[44:45]
    v_exp_f32 v136, v136
    v_exp_f32 v137, v137
    v_exp_f32 v138, v138
    v_exp_f32 v139, v139
    v_exp_f32 v140, v140
    v_exp_f32 v141, v141
    v_exp_f32 v142, v142
    v_exp_f32 v143, v143
    v_pk_add_f32 v[144:145], v[136:137], 2.0 op_sel_hi:[1,0]
    v_pk_add_f32 v[146:147], v[138:139], 2.0 op_sel_hi:[1,0]
    v_pk_add_f32 v[148:149], v[140:141], 2.0 op_sel_hi:[1,0]
    v_pk_add_f32 v[150:151], v[142:143], 2.0 op_sel_hi:[1,0]
    v_pk_fma_f32 v[136:137], v[136:137], v[144:145], 2.0 op_sel_hi:[1,1,0]
    v_pk_fma_f32 v[138:139], v[138:139], v[146:147], 2.0 op_sel_hi:[1,1,0]
    v_pk_fma_f32 v[140:141], v[140:141], v[148:149], 2.0 op_sel_hi:[1,1,0]
    v_pk_fma_f32 v[142:143], v[142:143], v[150:151], 2.0 op_sel_hi:[1,1,0]
    v_rcp_f32 v136, v136
    v_rcp_f32 v137, v137
    v_rcp_f32 v138, v138
    v_rcp_f32 v139, v139
    v_rcp_f32 v140, v140
    v_rcp_f32 v141, v141
    v_rcp_f32 v142, v142
    v_rcp_f32 v143, v143
    v_pk_fma_f32 v[136:137], v[136:137], -2.0, 1.0 op_sel_hi:[1,0,0]
    v_pk_fma_f32 v[138:139], v[138:139], -2.0, 1.0 op_sel_hi:[1,0,0]
    v_pk_fma_f32 v[140:141], v[140:141], -2.0, 1.0 op_sel_hi:[1,0,0]
    v_pk_fma_f32 v[142:143], v[142:143], -2.0, 1.0 op_sel_hi:[1,0,0]
    v_pk_mul_f32 v[48:49], v[48:49], v[136:137]
    v_pk_mul_f32 v[50:51], v[50:51], v[138:139]
    v_pk_mul_f32 v[52:53], v[52:53], v[140:141]
    v_pk_mul_f32 v[54:55], v[54:55], v[142:143]
    v_cvt_pk_bf16_f32 v156, v48, v49
    v_cvt_pk_bf16_f32 v157, v50, v51
    v_cvt_pk_bf16_f32 v158, v52, v53
    v_cvt_pk_bf16_f32 v159, v54, v55
    buffer_store_dwordx4 v[156:159], v3, s[20:23], s55 offen offset:1024 sc1
    v_pk_fma_f32 v[136:137], v[72:73], v[202:203], v[104:105] op_sel:[0,1,0] op_sel_hi:[1,1,1] neg_lo:[1,0,0] neg_hi:[1,0,0]
    v_pk_fma_f32 v[138:139], v[74:75], v[202:203], v[106:107] op_sel:[0,1,0] op_sel_hi:[1,1,1] neg_lo:[1,0,0] neg_hi:[1,0,0]
    v_pk_fma_f32 v[140:141], v[76:77], v[202:203], v[108:109] op_sel:[0,1,0] op_sel_hi:[1,1,1] neg_lo:[1,0,0] neg_hi:[1,0,0]
    v_pk_fma_f32 v[142:143], v[78:79], v[202:203], v[110:111] op_sel:[0,1,0] op_sel_hi:[1,1,1] neg_lo:[1,0,0] neg_hi:[1,0,0]
    v_pk_fma_f32 v[24:25], v[24:25], v[202:203], v[136:137] op_sel:[0,0,0] op_sel_hi:[1,0,1]
    v_pk_fma_f32 v[26:27], v[26:27], v[202:203], v[138:139] op_sel:[0,0,0] op_sel_hi:[1,0,1]
    v_pk_fma_f32 v[28:29], v[28:29], v[202:203], v[140:141] op_sel:[0,0,0] op_sel_hi:[1,0,1]
    v_pk_fma_f32 v[30:31], v[30:31], v[202:203], v[142:143] op_sel:[0,0,0] op_sel_hi:[1,0,1]
    v_pk_mul_f32 v[136:137], v[24:25], s[44:45]
    v_pk_mul_f32 v[138:139], v[26:27], s[44:45]
    v_pk_mul_f32 v[140:141], v[28:29], s[44:45]
    v_pk_mul_f32 v[142:143], v[30:31], s[44:45]
    v_exp_f32 v136, v136
    v_exp_f32 v137, v137
    v_exp_f32 v138, v138
    v_exp_f32 v139, v139
    v_exp_f32 v140, v140
    v_exp_f32 v141, v141
    v_exp_f32 v142, v142
    v_exp_f32 v143, v143
    v_pk_add_f32 v[144:145], v[136:137], 2.0 op_sel_hi:[1,0]
    v_pk_add_f32 v[146:147], v[138:139], 2.0 op_sel_hi:[1,0]
    v_pk_add_f32 v[148:149], v[140:141], 2.0 op_sel_hi:[1,0]
    v_pk_add_f32 v[150:151], v[142:143], 2.0 op_sel_hi:[1,0]
    v_pk_fma_f32 v[136:137], v[136:137], v[144:145], 2.0 op_sel_hi:[1,1,0]
    v_pk_fma_f32 v[138:139], v[138:139], v[146:147], 2.0 op_sel_hi:[1,1,0]
    v_pk_fma_f32 v[140:141], v[140:141], v[148:149], 2.0 op_sel_hi:[1,1,0]
    v_pk_fma_f32 v[142:143], v[142:143], v[150:151], 2.0 op_sel_hi:[1,1,0]
    v_rcp_f32 v136, v136
    v_rcp_f32 v137, v137
    v_rcp_f32 v138, v138
    v_rcp_f32 v139, v139
    v_rcp_f32 v140, v140
    v_rcp_f32 v141, v141
    v_rcp_f32 v142, v142
    v_rcp_f32 v143, v143
    v_pk_fma_f32 v[136:137], v[136:137], -2.0, 1.0 op_sel_hi:[1,0,0]
    v_pk_fma_f32 v[138:139], v[138:139], -2.0, 1.0 op_sel_hi:[1,0,0]
    v_pk_fma_f32 v[140:141], v[140:141], -2.0, 1.0 op_sel_hi:[1,0,0]
    v_pk_fma_f32 v[142:143], v[142:143], -2.0, 1.0 op_sel_hi:[1,0,0]
    v_pk_mul_f32 v[24:25], v[24:25], v[136:137]
    v_pk_mul_f32 v[26:27], v[26:27], v[138:139]
    v_pk_mul_f32 v[28:29], v[28:29], v[140:141]
    v_pk_mul_f32 v[30:31], v[30:31], v[142:143]
    v_cvt_pk_bf16_f32 v152, v24, v25
    v_cvt_pk_bf16_f32 v153, v26, v27
    v_cvt_pk_bf16_f32 v154, v28, v29
    v_cvt_pk_bf16_f32 v155, v30, v31
    buffer_store_dwordx4 v[152:155], v3, s[20:23], s56 offen offset:0 sc1
    v_pk_fma_f32 v[136:137], v[80:81], v[202:203], v[112:113] op_sel:[0,1,0] op_sel_hi:[1,1,1] neg_lo:[1,0,0] neg_hi:[1,0,0]
    v_pk_fma_f32 v[138:139], v[82:83], v[202:203], v[114:115] op_sel:[0,1,0] op_sel_hi:[1,1,1] neg_lo:[1,0,0] neg_hi:[1,0,0]
    v_pk_fma_f32 v[140:141], v[84:85], v[202:203], v[116:117] op_sel:[0,1,0] op_sel_hi:[1,1,1] neg_lo:[1,0,0] neg_hi:[1,0,0]
    v_pk_fma_f32 v[142:143], v[86:87], v[202:203], v[118:119] op_sel:[0,1,0] op_sel_hi:[1,1,1] neg_lo:[1,0,0] neg_hi:[1,0,0]
    v_pk_fma_f32 v[32:33], v[32:33], v[202:203], v[136:137] op_sel:[0,0,0] op_sel_hi:[1,0,1]
    v_pk_fma_f32 v[34:35], v[34:35], v[202:203], v[138:139] op_sel:[0,0,0] op_sel_hi:[1,0,1]
    v_pk_fma_f32 v[36:37], v[36:37], v[202:203], v[140:141] op_sel:[0,0,0] op_sel_hi:[1,0,1]
    v_pk_fma_f32 v[38:39], v[38:39], v[202:203], v[142:143] op_sel:[0,0,0] op_sel_hi:[1,0,1]
    v_pk_mul_f32 v[136:137], v[32:33], s[44:45]
    v_pk_mul_f32 v[138:139], v[34:35], s[44:45]
    v_pk_mul_f32 v[140:141], v[36:37], s[44:45]
    v_pk_mul_f32 v[142:143], v[38:39], s[44:45]
    v_exp_f32 v136, v136
    v_exp_f32 v137, v137
    v_exp_f32 v138, v138
    v_exp_f32 v139, v139
    v_exp_f32 v140, v140
    v_exp_f32 v141, v141
    v_exp_f32 v142, v142
    v_exp_f32 v143, v143
    v_pk_add_f32 v[144:145], v[136:137], 2.0 op_sel_hi:[1,0]
    v_pk_add_f32 v[146:147], v[138:139], 2.0 op_sel_hi:[1,0]
    v_pk_add_f32 v[148:149], v[140:141], 2.0 op_sel_hi:[1,0]
    v_pk_add_f32 v[150:151], v[142:143], 2.0 op_sel_hi:[1,0]
    v_pk_fma_f32 v[136:137], v[136:137], v[144:145], 2.0 op_sel_hi:[1,1,0]
    v_pk_fma_f32 v[138:139], v[138:139], v[146:147], 2.0 op_sel_hi:[1,1,0]
    v_pk_fma_f32 v[140:141], v[140:141], v[148:149], 2.0 op_sel_hi:[1,1,0]
    v_pk_fma_f32 v[142:143], v[142:143], v[150:151], 2.0 op_sel_hi:[1,1,0]
    v_rcp_f32 v136, v136
    v_rcp_f32 v137, v137
    v_rcp_f32 v138, v138
    v_rcp_f32 v139, v139
    v_rcp_f32 v140, v140
    v_rcp_f32 v141, v141
    v_rcp_f32 v142, v142
    v_rcp_f32 v143, v143
    v_pk_fma_f32 v[136:137], v[136:137], -2.0, 1.0 op_sel_hi:[1,0,0]
    v_pk_fma_f32 v[138:139], v[138:139], -2.0, 1.0 op_sel_hi:[1,0,0]
    v_pk_fma_f32 v[140:141], v[140:141], -2.0, 1.0 op_sel_hi:[1,0,0]
    v_pk_fma_f32 v[142:143], v[142:143], -2.0, 1.0 op_sel_hi:[1,0,0]
    v_pk_mul_f32 v[32:33], v[32:33], v[136:137]
    v_pk_mul_f32 v[34:35], v[34:35], v[138:139]
    v_pk_mul_f32 v[36:37], v[36:37], v[140:141]
    v_pk_mul_f32 v[38:39], v[38:39], v[142:143]
    v_cvt_pk_bf16_f32 v156, v32, v33
    v_cvt_pk_bf16_f32 v157, v34, v35
    v_cvt_pk_bf16_f32 v158, v36, v37
    v_cvt_pk_bf16_f32 v159, v38, v39
    buffer_store_dwordx4 v[156:159], v3, s[20:23], s56 offen offset:1024 sc1
    v_pk_fma_f32 v[136:137], v[88:89], v[202:203], v[120:121] op_sel:[0,1,0] op_sel_hi:[1,1,1] neg_lo:[1,0,0] neg_hi:[1,0,0]
    v_pk_fma_f32 v[138:139], v[90:91], v[202:203], v[122:123] op_sel:[0,1,0] op_sel_hi:[1,1,1] neg_lo:[1,0,0] neg_hi:[1,0,0]
    v_pk_fma_f32 v[140:141], v[92:93], v[202:203], v[124:125] op_sel:[0,1,0] op_sel_hi:[1,1,1] neg_lo:[1,0,0] neg_hi:[1,0,0]
    v_pk_fma_f32 v[142:143], v[94:95], v[202:203], v[126:127] op_sel:[0,1,0] op_sel_hi:[1,1,1] neg_lo:[1,0,0] neg_hi:[1,0,0]
    v_pk_fma_f32 v[56:57], v[56:57], v[202:203], v[136:137] op_sel:[0,0,0] op_sel_hi:[1,0,1]
    v_pk_fma_f32 v[58:59], v[58:59], v[202:203], v[138:139] op_sel:[0,0,0] op_sel_hi:[1,0,1]
    v_pk_fma_f32 v[60:61], v[60:61], v[202:203], v[140:141] op_sel:[0,0,0] op_sel_hi:[1,0,1]
    v_pk_fma_f32 v[62:63], v[62:63], v[202:203], v[142:143] op_sel:[0,0,0] op_sel_hi:[1,0,1]
    v_pk_mul_f32 v[136:137], v[56:57], s[44:45]
    v_pk_mul_f32 v[138:139], v[58:59], s[44:45]
    v_pk_mul_f32 v[140:141], v[60:61], s[44:45]
    v_pk_mul_f32 v[142:143], v[62:63], s[44:45]
    v_exp_f32 v136, v136
    v_exp_f32 v137, v137
    v_exp_f32 v138, v138
    v_exp_f32 v139, v139
    v_exp_f32 v140, v140
    v_exp_f32 v141, v141
    v_exp_f32 v142, v142
    v_exp_f32 v143, v143
    v_pk_add_f32 v[144:145], v[136:137], 2.0 op_sel_hi:[1,0]
    v_pk_add_f32 v[146:147], v[138:139], 2.0 op_sel_hi:[1,0]
    v_pk_add_f32 v[148:149], v[140:141], 2.0 op_sel_hi:[1,0]
    v_pk_add_f32 v[150:151], v[142:143], 2.0 op_sel_hi:[1,0]
    v_pk_fma_f32 v[136:137], v[136:137], v[144:145], 2.0 op_sel_hi:[1,1,0]
    v_pk_fma_f32 v[138:139], v[138:139], v[146:147], 2.0 op_sel_hi:[1,1,0]
    v_pk_fma_f32 v[140:141], v[140:141], v[148:149], 2.0 op_sel_hi:[1,1,0]
    v_pk_fma_f32 v[142:143], v[142:143], v[150:151], 2.0 op_sel_hi:[1,1,0]
    v_rcp_f32 v136, v136
    v_rcp_f32 v137, v137
    v_rcp_f32 v138, v138
    v_rcp_f32 v139, v139
    v_rcp_f32 v140, v140
    v_rcp_f32 v141, v141
    v_rcp_f32 v142, v142
    v_rcp_f32 v143, v143
    v_pk_fma_f32 v[136:137], v[136:137], -2.0, 1.0 op_sel_hi:[1,0,0]
    v_pk_fma_f32 v[138:139], v[138:139], -2.0, 1.0 op_sel_hi:[1,0,0]
    v_pk_fma_f32 v[140:141], v[140:141], -2.0, 1.0 op_sel_hi:[1,0,0]
    v_pk_fma_f32 v[142:143], v[142:143], -2.0, 1.0 op_sel_hi:[1,0,0]
    v_pk_mul_f32 v[56:57], v[56:57], v[136:137]
    v_pk_mul_f32 v[58:59], v[58:59], v[138:139]
    v_pk_mul_f32 v[60:61], v[60:61], v[140:141]
    v_pk_mul_f32 v[62:63], v[62:63], v[142:143]
    v_cvt_pk_bf16_f32 v152, v56, v57
    v_cvt_pk_bf16_f32 v153, v58, v59
    v_cvt_pk_bf16_f32 v154, v60, v61
    v_cvt_pk_bf16_f32 v155, v62, v63
    buffer_store_dwordx4 v[152:155], v3, s[20:23], s57 offen offset:0 sc1
    v_pk_fma_f32 v[136:137], v[96:97], v[202:203], v[128:129] op_sel:[0,1,0] op_sel_hi:[1,1,1] neg_lo:[1,0,0] neg_hi:[1,0,0]
    v_pk_fma_f32 v[138:139], v[98:99], v[202:203], v[130:131] op_sel:[0,1,0] op_sel_hi:[1,1,1] neg_lo:[1,0,0] neg_hi:[1,0,0]
    v_pk_fma_f32 v[140:141], v[100:101], v[202:203], v[132:133] op_sel:[0,1,0] op_sel_hi:[1,1,1] neg_lo:[1,0,0] neg_hi:[1,0,0]
    v_pk_fma_f32 v[142:143], v[102:103], v[202:203], v[134:135] op_sel:[0,1,0] op_sel_hi:[1,1,1] neg_lo:[1,0,0] neg_hi:[1,0,0]
    v_pk_fma_f32 v[64:65], v[64:65], v[202:203], v[136:137] op_sel:[0,0,0] op_sel_hi:[1,0,1]
    v_pk_fma_f32 v[66:67], v[66:67], v[202:203], v[138:139] op_sel:[0,0,0] op_sel_hi:[1,0,1]
    v_pk_fma_f32 v[68:69], v[68:69], v[202:203], v[140:141] op_sel:[0,0,0] op_sel_hi:[1,0,1]
    v_pk_fma_f32 v[70:71], v[70:71], v[202:203], v[142:143] op_sel:[0,0,0] op_sel_hi:[1,0,1]
    v_pk_mul_f32 v[136:137], v[64:65], s[44:45]
    v_pk_mul_f32 v[138:139], v[66:67], s[44:45]
    v_pk_mul_f32 v[140:141], v[68:69], s[44:45]
    v_pk_mul_f32 v[142:143], v[70:71], s[44:45]
    v_exp_f32 v136, v136
    v_exp_f32 v137, v137
    v_exp_f32 v138, v138
    v_exp_f32 v139, v139
    v_exp_f32 v140, v140
    v_exp_f32 v141, v141
    v_exp_f32 v142, v142
    v_exp_f32 v143, v143
    v_pk_add_f32 v[144:145], v[136:137], 2.0 op_sel_hi:[1,0]
    v_pk_add_f32 v[146:147], v[138:139], 2.0 op_sel_hi:[1,0]
    v_pk_add_f32 v[148:149], v[140:141], 2.0 op_sel_hi:[1,0]
    v_pk_add_f32 v[150:151], v[142:143], 2.0 op_sel_hi:[1,0]
    v_pk_fma_f32 v[136:137], v[136:137], v[144:145], 2.0 op_sel_hi:[1,1,0]
    v_pk_fma_f32 v[138:139], v[138:139], v[146:147], 2.0 op_sel_hi:[1,1,0]
    v_pk_fma_f32 v[140:141], v[140:141], v[148:149], 2.0 op_sel_hi:[1,1,0]
    v_pk_fma_f32 v[142:143], v[142:143], v[150:151], 2.0 op_sel_hi:[1,1,0]
    v_rcp_f32 v136, v136
    v_rcp_f32 v137, v137
    v_rcp_f32 v138, v138
    v_rcp_f32 v139, v139
    v_rcp_f32 v140, v140
    v_rcp_f32 v141, v141
    v_rcp_f32 v142, v142
    v_rcp_f32 v143, v143
    v_pk_fma_f32 v[136:137], v[136:137], -2.0, 1.0 op_sel_hi:[1,0,0]
    v_pk_fma_f32 v[138:139], v[138:139], -2.0, 1.0 op_sel_hi:[1,0,0]
    v_pk_fma_f32 v[140:141], v[140:141], -2.0, 1.0 op_sel_hi:[1,0,0]
    v_pk_fma_f32 v[142:143], v[142:143], -2.0, 1.0 op_sel_hi:[1,0,0]
    v_pk_mul_f32 v[64:65], v[64:65], v[136:137]
    v_pk_mul_f32 v[66:67], v[66:67], v[138:139]
    v_pk_mul_f32 v[68:69], v[68:69], v[140:141]
    v_pk_mul_f32 v[70:71], v[70:71], v[142:143]
    v_cvt_pk_bf16_f32 v156, v64, v65
    v_cvt_pk_bf16_f32 v157, v66, v67
    v_cvt_pk_bf16_f32 v158, v68, v69
    v_cvt_pk_bf16_f32 v159, v70, v71
    buffer_store_dwordx4 v[156:159], v3, s[20:23], s57 offen offset:1024 sc1
    s_endpgm
L0_other:
    s_sub_u32 s62, s2, 224
    s_cmp_lt_u32 s62, 32
    s_cbranch_scc0 Lpf_skip0

    s_getpc_b64 s[60:61]
Lpf_here0:

    s_sub_u32 s60, s60, Lpf_here0-p0_kernel
    s_subb_u32 s61, s61, 0
    s_mov_b32 s62, Lcode_end-p0_kernel

    v_lshlrev_b32 v4, 7, v0

    v_cmp_gt_u32 vcc, s62, v4
    s_and_saveexec_b64 s[64:65], vcc
    s_cbranch_execz Lpf_e0_0
    v_mov_b32 v3, s61
    v_add_co_u32 v2, vcc, s60, v4
    v_addc_co_u32 v3, vcc, 0, v3, vcc
    global_load_dword v239, v[2:3], off
Lpf_e0_0:
    s_mov_b64 exec, s[64:65]
    v_add_u32 v4, 32768, v4

    v_cmp_gt_u32 vcc, s62, v4
    s_and_saveexec_b64 s[64:65], vcc
    s_cbranch_execz Lpf_e0_1
    v_mov_b32 v3, s61
    v_add_co_u32 v2, vcc, s60, v4
    v_addc_co_u32 v3, vcc, 0, v3, vcc
    global_load_dword v239, v[2:3], off
Lpf_e0_1:
    s_mov_b64 exec, s[64:65]
    v_add_u32 v4, 32768, v4

Lpf_skip0:
    s_cmp_lt_u32 s2, 256
    s_cbranch_scc1 L0_lnA
    s_cmp_lt_u32 s2, 480
    s_cbranch_scc0 L0_ln
    s_sub_u32 s48, s2, 256
    s_lshl_b32 s48, s48, 1

    s_setprio 1
    s_load_dwordx4 s[4:7], s[0:1], 8
    s_load_dwordx4 s[8:11], s[0:1], 24
    s_load_dwordx4 s[12:15], s[0:1], 40
    s_load_dwordx2 s[16:17], s[0:1], 104
    v_and_b32 v1, 63, v0
    v_lshrrev_b32 v2, 6, v0
    s_lshl_b32 s18, s48, 9
    v_lshlrev_b32 v3, 1, v0
    v_add_u32 v3, s18, v3
    s_lshl_b32 s19, s48, 1
    s_and_b32 s19, s19, 0xfffffffc
    s_waitcnt lgkmcnt(0)

    s_mov_b32 s20, s4
    s_mov_b32 s21, s5
    s_mov_b32 s22, 229376
    s_mov_b32 s23, 0x00020000
    s_mov_b32 s24, s6
    s_mov_b32 s25, s7
    s_mov_b32 s26, 229376
    s_mov_b32 s27, 0x00020000
    s_mov_b32 s28, s8
    s_mov_b32 s29, s9
    s_mov_b32 s30, 229376
    s_mov_b32 s31, 0x00020000
    s_mov_b32 s32, s10
    s_mov_b32 s33, s11
    s_mov_b32 s34, 229376
    s_mov_b32 s35, 0x00020000
    buffer_load_ushort v4, v3, s[20:23], 0 offen
    buffer_load_ushort v5, v3, s[24:27], 0 offen
    buffer_load_ushort v6, v3, s[28:31], 0 offen
    buffer_load_ushort v7, v3, s[32:35], 0 offen
    s_load_dword s58, s[12:13], s19
    s_load_dword s59, s[14:15], s19

    buffer_load_ushort v140, v3, s[20:23], 0 offen offset:512
    buffer_load_ushort v141, v3, s[24:27], 0 offen offset:512
    buffer_load_ushort v142, v3, s[28:31], 0 offen offset:512
    buffer_load_ushort v143, v3, s[32:35], 0 offen offset:512
    s_mov_b32 s40, s16
    s_mov_b32 s41, s17
    s_mov_b32 s42, 1835008
    s_mov_b32 s43, 0x00020000
    v_mov_b32 v10, 0
    v_cmp_le_u32 vcc, 32, v0
    v_lshlrev_b32 v14, 3, v0
    v_addc_co_u32 v10, vcc, 0, v10, vcc
    v_cmp_le_u32 vcc, 64, v0
    s_nop 1
    v_addc_co_u32 v10, vcc, 0, v10, vcc
    v_cmp_le_u32 vcc, 128, v0
    s_nop 1
    v_addc_co_u32 v10, vcc, 0, v10, vcc
    v_mov_b32 v15, 1
    v_lshlrev_b32 v11, v10, v15
    v_lshrrev_b32 v11, 1, v11
    v_min_u32 v12, 1, v10
    v_sub_u32 v11, v11, v12
    v_lshlrev_b32 v13, 9, v10
    v_add_u32 v13, 17408, v13

    v_add_u32 v15, 0, v14
    v_lshrrev_b32 v16, v10, v15
    v_and_b32 v16, v16, v12
    v_add3_u32 v15, v15, v11, v16
    v_lshrrev_b32 v15, v10, v15
    v_lshl_add_u32 v100, v15, 2, v13

    v_add_u32 v15, 1, v14
    v_lshrrev_b32 v16, v10, v15
    v_and_b32 v16, v16, v12
    v_add3_u32 v15, v15, v11, v16
    v_lshrrev_b32 v15, v10, v15
    v_lshl_add_u32 v101, v15, 2, v13

    v_add_u32 v15, 2, v14
    v_lshrrev_b32 v16, v10, v15
    v_and_b32 v16, v16, v12
    v_add3_u32 v15, v15, v11, v16
    v_lshrrev_b32 v15, v10, v15
    v_lshl_add_u32 v102, v15, 2, v13

    v_add_u32 v15, 3, v14
    v_lshrrev_b32 v16, v10, v15
    v_and_b32 v16, v16, v12
    v_add3_u32 v15, v15, v11, v16
    v_lshrrev_b32 v15, v10, v15
    v_lshl_add_u32 v103, v15, 2, v13

    v_add_u32 v15, 4, v14
    v_lshrrev_b32 v16, v10, v15
    v_and_b32 v16, v16, v12
    v_add3_u32 v15, v15, v11, v16
    v_lshrrev_b32 v15, v10, v15
    v_lshl_add_u32 v104, v15, 2, v13

    v_add_u32 v15, 5, v14
    v_lshrrev_b32 v16, v10, v15
    v_and_b32 v16, v16, v12
    v_add3_u32 v15, v15, v11, v16
    v_lshrrev_b32 v15, v10, v15
    v_lshl_add_u32 v105, v15, 2, v13

    v_add_u32 v15, 6, v14
    v_lshrrev_b32 v16, v10, v15
    v_and_b32 v16, v16, v12
    v_add3_u32 v15, v15, v11, v16
    v_lshrrev_b32 v15, v10, v15
    v_lshl_add_u32 v106, v15, 2, v13

    v_add_u32 v15, 7, v14
    v_lshrrev_b32 v16, v10, v15
    v_and_b32 v16, v16, v12
    v_add3_u32 v15, v15, v11, v16
    v_lshrrev_b32 v15, v10, v15
    v_lshl_add_u32 v107, v15, 2, v13

    v_mul_u32_u24 v19, 4352, v2
    v_add_u32 v19, 0, v19
    v_lshl_add_u32 v17, v1, 2, v19
    v_and_b32 v20, 15, v1
    v_lshrrev_b32 v21, 4, v1
    v_mul_u32_u24 v18, 272, v20
    v_add_u32 v18, v18, v19
    v_lshl_add_u32 v18, v21, 4, v18

    v_and_b32 v22, 1, v21
    v_lshrrev_b32 v23, 1, v21
    v_lshlrev_b32 v24, 5, v20
    v_lshl_add_u32 v24, v22, 4, v24
    v_lshl_add_u32 v24, v23, 9, v24
    v_add_u32 v90, 17408, v24

    v_lshlrev_b32 v24, 4, v20
    v_lshl_add_u32 v24, v21, 8, v24
    v_add_u32 v24, 18432, v24
    v_lshlrev_b32 v25, 3, v20
    v_lshl_add_u32 v25, v21, 8, v25
    v_add_u32 v25, 18432, v25
    v_cmp_gt_u32 vcc, 2, v21
    v_add_u32 v26, 8, v24
    v_add_u32 v27, 128, v25
    v_cndmask_b32 v91, v25, v24, vcc
    v_cndmask_b32 v92, v27, v26, vcc

    v_lshlrev_b32 v24, 2, v20
    v_lshl_add_u32 v25, v21, 8, v24
    v_add_u32 v25, 19456, v25
    v_add_u32 v26, 20096, v24
    v_cmp_gt_u32 vcc, 3, v21
    s_nop 1
    v_cndmask_b32 v93, v26, v25, vcc
    v_cmp_gt_u32 vcc, 2, v21
    v_add_u32 v27, 64, v25
    s_nop 0
    v_cndmask_b32 v94, v26, v27, vcc

    s_waitcnt lgkmcnt(0)
Lkgloop_1001:
    s_waitcnt lgkmcnt(0)
    s_and_b32 s44, s48, 1
    s_lshl_b32 s44, s44, 4
    s_lshr_b32 s36, s58, s44
    s_lshl_b32 s36, s36, 16
    s_lshr_b32 s37, s59, s44
    s_lshl_b32 s37, s37, 16
    s_mov_b32 s45, 0x3fb8aa3b
    s_mov_b32 s46, 0x3e22f983
    v_mov_b32 v28, s36
    v_mul_f32 v28, s45, v28
    v_exp_f32 v28, v28
    s_nop 0
    v_cvt_pk_bf16_f32 v28, v28, v28
    v_and_b32 v28, 0xffff0000, v28
    s_waitcnt vmcnt(4)

    v_lshlrev_b32 v4, 16, v4
    v_lshlrev_b32 v5, 16, v5
    v_lshlrev_b32 v6, 16, v6
    v_lshlrev_b32 v7, 16, v7
    v_mul_f32 v4, s45, v4
    v_exp_f32 v4, v4
    v_mul_f32 v5, v28, v5
    v_cvt_pk_bf16_f32 v4, v4, v4
    v_and_b32 v4, 0xffff0000, v4
    v_mul_f32 v4, v28, v4
    v_mul_f32 v4, s45, v4
    v_mul_f32 v5, s46, v5
    v_add_f32 v28, v28, v28
    v_mul_f32 v30, v28, v6
    v_mul_f32 v31, v28, v7

    v_mul_f32 v8, 0xc1000000, v4
    v_mul_f32 v9, 0x41000000, v5
    v_exp_f32 v8, v8
    v_fract_f32 v9, v9
    s_nop 0
    v_cos_f32 v10, v9
    v_sin_f32 v11, v9
    s_nop 0
    v_mul_f32 v48, v8, v10
    v_mul_f32_e64 v49, -v8, v11
    v_mul_f32 v8, 0xbf800000, v4
    v_mul_f32 v9, 0x3f800000, v5
    v_exp_f32 v8, v8
    v_fract_f32 v9, v9
    s_nop 0
    v_cos_f32 v10, v9
    v_sin_f32 v11, v9
    s_nop 0
    v_mul_f32 v32, v8, v10
    v_mul_f32 v33, v8, v11
    v_mul_f32 v8, 0xc3000000, v4
    v_mul_f32 v9, 0x43000000, v5
    v_exp_f32 v8, v8
    v_fract_f32 v9, v9
    s_nop 0
    v_cos_f32 v10, v9
    v_sin_f32 v11, v9
    s_nop 0
    v_mul_f32 v46, v8, v10
    v_mul_f32 v47, v8, v11
    v_mov_b32 v12, 0x00003f80
    ds_write_b32 v17, v12 offset:0
    v_cvt_pk_bf16_f32 v12, v48, v49
    ds_write_b32 v17, v12 offset:272
    v_pk_mul_f32 v[50:51], v[48:49], v[48:49] op_sel:[0,0] op_sel_hi:[0,1]
    v_pk_fma_f32 v[50:51], v[48:49], v[48:49], v[50:51] op_sel:[1,1,0] op_sel_hi:[1,0,1] neg_lo:[0,1,0]
    v_pk_mul_f32 v[34:35], v[32:33], v[32:33] op_sel:[0,0] op_sel_hi:[0,1]
    v_pk_fma_f32 v[34:35], v[32:33], v[32:33], v[34:35] op_sel:[1,1,0] op_sel_hi:[1,0,1] neg_lo:[0,1,0]
    v_cvt_pk_bf16_f32 v13, v50, v51
    ds_write_b32 v17, v13 offset:544
    v_pk_mul_f32 v[52:53], v[50:51], v[48:49] op_sel:[0,0] op_sel_hi:[0,1]
    v_pk_fma_f32 v[52:53], v[50:51], v[48:49], v[52:53] op_sel:[1,1,0] op_sel_hi:[1,0,1] neg_lo:[0,1,0]
    v_pk_mul_f32 v[54:55], v[50:51], v[50:51] op_sel:[0,0] op_sel_hi:[0,1]
    v_pk_fma_f32 v[54:55], v[50:51], v[50:51], v[54:55] op_sel:[1,1,0] op_sel_hi:[1,0,1] neg_lo:[0,1,0]
    v_pk_mul_f32 v[36:37], v[34:35], v[32:33] op_sel:[0,0] op_sel_hi:[0,1]
    v_pk_fma_f32 v[36:37], v[34:35], v[32:33], v[36:37] op_sel:[1,1,0] op_sel_hi:[1,0,1] neg_lo:[0,1,0]
    v_pk_mul_f32 v[38:39], v[34:35], v[34:35] op_sel:[0,0] op_sel_hi:[0,1]
    v_pk_fma_f32 v[38:39], v[34:35], v[34:35], v[38:39] op_sel:[1,1,0] op_sel_hi:[1,0,1] neg_lo:[0,1,0]
    v_cvt_pk_bf16_f32 v14, v52, v53
    ds_write_b32 v17, v14 offset:816
    v_cvt_pk_bf16_f32 v15, v54, v55
    ds_write_b32 v17, v15 offset:1088
    v_pk_mul_f32 v[56:57], v[54:55], v[48:49] op_sel:[0,0] op_sel_hi:[0,1]
    v_pk_fma_f32 v[56:57], v[54:55], v[48:49], v[56:57] op_sel:[1,1,0] op_sel_hi:[1,0,1] neg_lo:[0,1,0]
    v_pk_mul_f32 v[58:59], v[54:55], v[50:51] op_sel:[0,0] op_sel_hi:[0,1]
    v_pk_fma_f32 v[58:59], v[54:55], v[50:51], v[58:59] op_sel:[1,1,0] op_sel_hi:[1,0,1] neg_lo:[0,1,0]
    v_pk_mul_f32 v[60:61], v[54:55], v[52:53] op_sel:[0,0] op_sel_hi:[0,1]
    v_pk_fma_f32 v[60:61], v[54:55], v[52:53], v[60:61] op_sel:[1,1,0] op_sel_hi:[1,0,1] neg_lo:[0,1,0]
    v_pk_mul_f32 v[62:63], v[54:55], v[54:55] op_sel:[0,0] op_sel_hi:[0,1]
    v_pk_fma_f32 v[62:63], v[54:55], v[54:55], v[62:63] op_sel:[1,1,0] op_sel_hi:[1,0,1] neg_lo:[0,1,0]
    v_cvt_pk_bf16_f32 v12, v56, v57
    ds_write_b32 v17, v12 offset:1360
    v_cvt_pk_bf16_f32 v13, v58, v59
    ds_write_b32 v17, v13 offset:1632
    v_cvt_pk_bf16_f32 v14, v60, v61
    ds_write_b32 v17, v14 offset:1904
    v_cvt_pk_bf16_f32 v15, v62, v63
    ds_write_b32 v17, v15 offset:2176
    v_pk_mul_f32 v[66:67], v[62:63], v[48:49] op_sel:[0,0] op_sel_hi:[0,1]
    v_pk_fma_f32 v[66:67], v[62:63], v[48:49], v[66:67] op_sel:[1,1,0] op_sel_hi:[1,0,1] neg_lo:[0,1,0]
    v_cvt_pk_bf16_f32 v12, v66, v67
    ds_write_b32 v17, v12 offset:2448
    v_pk_mul_f32 v[68:69], v[62:63], v[50:51] op_sel:[0,0] op_sel_hi:[0,1]
    v_pk_fma_f32 v[68:69], v[62:63], v[50:51], v[68:69] op_sel:[1,1,0] op_sel_hi:[1,0,1] neg_lo:[0,1,0]
    v_cvt_pk_bf16_f32 v13, v68, v69
    ds_write_b32 v17, v13 offset:2720
    v_pk_mul_f32 v[70:71], v[62:63], v[52:53] op_sel:[0,0] op_sel_hi:[0,1]
    v_pk_fma_f32 v[70:71], v[62:63], v[52:53], v[70:71] op_sel:[1,1,0] op_sel_hi:[1,0,1] neg_lo:[0,1,0]
    v_cvt_pk_bf16_f32 v14, v70, v71
    ds_write_b32 v17, v14 offset:2992
    v_pk_mul_f32 v[64:65], v[62:63], v[54:55] op_sel:[0,0] op_sel_hi:[0,1]
    v_pk_fma_f32 v[64:65], v[62:63], v[54:55], v[64:65] op_sel:[1,1,0] op_sel_hi:[1,0,1] neg_lo:[0,1,0]
    v_cvt_pk_bf16_f32 v15, v64, v65
    ds_write_b32 v17, v15 offset:3264
    v_pk_mul_f32 v[66:67], v[62:63], v[56:57] op_sel:[0,0] op_sel_hi:[0,1]
    v_pk_fma_f32 v[66:67], v[62:63], v[56:57], v[66:67] op_sel:[1,1,0] op_sel_hi:[1,0,1] neg_lo:[0,1,0]
    v_cvt_pk_bf16_f32 v12, v66, v67
    ds_write_b32 v17, v12 offset:3536
    v_pk_mul_f32 v[68:69], v[62:63], v[58:59] op_sel:[0,0] op_sel_hi:[0,1]
    v_pk_fma_f32 v[68:69], v[62:63], v[58:59], v[68:69] op_sel:[1,1,0] op_sel_hi:[1,0,1] neg_lo:[0,1,0]
    v_cvt_pk_bf16_f32 v13, v68, v69
    ds_write_b32 v17, v13 offset:3808
    v_pk_mul_f32 v[70:71], v[62:63], v[60:61] op_sel:[0,0] op_sel_hi:[0,1]
    v_pk_fma_f32 v[70:71], v[62:63], v[60:61], v[70:71] op_sel:[1,1,0] op_sel_hi:[1,0,1] neg_lo:[0,1,0]
    v_cvt_pk_bf16_f32 v14, v70, v71
    ds_write_b32 v17, v14 offset:4080
    v_pk_mul_f32 v[40:41], v[38:39], v[32:33] op_sel:[0,0] op_sel_hi:[0,1]
    v_pk_fma_f32 v[40:41], v[38:39], v[32:33], v[40:41] op_sel:[1,1,0] op_sel_hi:[1,0,1] neg_lo:[0,1,0]
    v_pk_mul_f32 v[42:43], v[38:39], v[34:35] op_sel:[0,0] op_sel_hi:[0,1]
    v_pk_fma_f32 v[42:43], v[38:39], v[34:35], v[42:43] op_sel:[1,1,0] op_sel_hi:[1,0,1] neg_lo:[0,1,0]
    v_pk_mul_f32 v[44:45], v[38:39], v[36:37] op_sel:[0,0] op_sel_hi:[0,1]
    v_pk_fma_f32 v[44:45], v[38:39], v[36:37], v[44:45] op_sel:[1,1,0] op_sel_hi:[1,0,1] neg_lo:[0,1,0]
    s_waitcnt lgkmcnt(0)
    ds_read_b128 v[72:75], v18 offset:0
    ds_read_b128 v[76:79], v18 offset:64
    ds_read_b128 v[80:83], v18 offset:128
    ds_read_b128 v[84:87], v18 offset:192
    v_cvt_pk_bf16_f32 v15, v30, v31
    ds_write_b32 v17, v15 offset:0
    v_pk_mul_f32 v[50:51], v[30:31], v[46:47] op_sel:[0,0] op_sel_hi:[0,1]
    v_pk_fma_f32 v[50:51], v[30:31], v[46:47], v[50:51] op_sel:[1,1,0] op_sel_hi:[1,0,1] neg_lo:[0,1,0]
    v_pk_mul_f32 v[66:67], v[30:31], v[32:33] op_sel:[0,0] op_sel_hi:[0,1]
    v_pk_fma_f32 v[66:67], v[30:31], v[32:33], v[66:67] op_sel:[1,1,0] op_sel_hi:[1,0,1] neg_lo:[0,1,0]
    v_cvt_pk_bf16_f32 v12, v66, v67
    ds_write_b32 v17, v12 offset:272
    v_pk_mul_f32 v[68:69], v[30:31], v[34:35] op_sel:[0,0] op_sel_hi:[0,1]
    v_pk_fma_f32 v[68:69], v[30:31], v[34:35], v[68:69] op_sel:[1,1,0] op_sel_hi:[1,0,1] neg_lo:[0,1,0]
    v_cvt_pk_bf16_f32 v13, v68, v69
    ds_write_b32 v17, v13 offset:544
    v_pk_mul_f32 v[70:71], v[30:31], v[36:37] op_sel:[0,0] op_sel_hi:[0,1]
    v_pk_fma_f32 v[70:71], v[30:31], v[36:37], v[70:71] op_sel:[1,1,0] op_sel_hi:[1,0,1] neg_lo:[0,1,0]
    v_cvt_pk_bf16_f32 v14, v70, v71
    ds_write_b32 v17, v14 offset:816
    v_pk_mul_f32 v[64:65], v[30:31], v[38:39] op_sel:[0,0] op_sel_hi:[0,1]
    v_pk_fma_f32 v[64:65], v[30:31], v[38:39], v[64:65] op_sel:[1,1,0] op_sel_hi:[1,0,1] neg_lo:[0,1,0]
    v_cvt_pk_bf16_f32 v15, v64, v65
    ds_write_b32 v17, v15 offset:1088
    v_pk_mul_f32 v[66:67], v[30:31], v[40:41] op_sel:[0,0] op_sel_hi:[0,1]
    v_pk_fma_f32 v[66:67], v[30:31], v[40:41], v[66:67] op_sel:[1,1,0] op_sel_hi:[1,0,1] neg_lo:[0,1,0]
    v_cvt_pk_bf16_f32 v12, v66, v67
    ds_write_b32 v17, v12 offset:1360
    v_pk_mul_f32 v[68:69], v[30:31], v[42:43] op_sel:[0,0] op_sel_hi:[0,1]
    v_pk_fma_f32 v[68:69], v[30:31], v[42:43], v[68:69] op_sel:[1,1,0] op_sel_hi:[1,0,1] neg_lo:[0,1,0]
    v_cvt_pk_bf16_f32 v13, v68, v69
    ds_write_b32 v17, v13 offset:1632
    v_pk_mul_f32 v[70:71], v[30:31], v[44:45] op_sel:[0,0] op_sel_hi:[0,1]
    v_pk_fma_f32 v[70:71], v[30:31], v[44:45], v[70:71] op_sel:[1,1,0] op_sel_hi:[1,0,1] neg_lo:[0,1,0]
    v_cvt_pk_bf16_f32 v14, v70, v71
    ds_write_b32 v17, v14 offset:1904
    v_cvt_pk_bf16_f32 v15, v50, v51
    ds_write_b32 v17, v15 offset:2176
    v_pk_mul_f32 v[52:53], v[50:51], v[46:47] op_sel:[0,0] op_sel_hi:[0,1]
    v_pk_fma_f32 v[52:53], v[50:51], v[46:47], v[52:53] op_sel:[1,1,0] op_sel_hi:[1,0,1] neg_lo:[0,1,0]
    v_pk_mul_f32 v[66:67], v[50:51], v[32:33] op_sel:[0,0] op_sel_hi:[0,1]
    v_pk_fma_f32 v[66:67], v[50:51], v[32:33], v[66:67] op_sel:[1,1,0] op_sel_hi:[1,0,1] neg_lo:[0,1,0]
    v_cvt_pk_bf16_f32 v12, v66, v67
    ds_write_b32 v17, v12 offset:2448
    v_pk_mul_f32 v[68:69], v[50:51], v[34:35] op_sel:[0,0] op_sel_hi:[0,1]
    v_pk_fma_f32 v[68:69], v[50:51], v[34:35], v[68:69] op_sel:[1,1,0] op_sel_hi:[1,0,1] neg_lo:[0,1,0]
    v_cvt_pk_bf16_f32 v13, v68, v69
    ds_write_b32 v17, v13 offset:2720
    v_pk_mul_f32 v[70:71], v[50:51], v[36:37] op_sel:[0,0] op_sel_hi:[0,1]
    v_pk_fma_f32 v[70:71], v[50:51], v[36:37], v[70:71] op_sel:[1,1,0] op_sel_hi:[1,0,1] neg_lo:[0,1,0]
    v_cvt_pk_bf16_f32 v14, v70, v71
    ds_write_b32 v17, v14 offset:2992
    v_pk_mul_f32 v[64:65], v[50:51], v[38:39] op_sel:[0,0] op_sel_hi:[0,1]
    v_pk_fma_f32 v[64:65], v[50:51], v[38:39], v[64:65] op_sel:[1,1,0] op_sel_hi:[1,0,1] neg_lo:[0,1,0]
    v_cvt_pk_bf16_f32 v15, v64, v65
    ds_write_b32 v17, v15 offset:3264
    v_pk_mul_f32 v[66:67], v[50:51], v[40:41] op_sel:[0,0] op_sel_hi:[0,1]
    v_pk_fma_f32 v[66:67], v[50:51], v[40:41], v[66:67] op_sel:[1,1,0] op_sel_hi:[1,0,1] neg_lo:[0,1,0]
    v_cvt_pk_bf16_f32 v12, v66, v67
    ds_write_b32 v17, v12 offset:3536
    v_pk_mul_f32 v[68:69], v[50:51], v[42:43] op_sel:[0,0] op_sel_hi:[0,1]
    v_pk_fma_f32 v[68:69], v[50:51], v[42:43], v[68:69] op_sel:[1,1,0] op_sel_hi:[1,0,1] neg_lo:[0,1,0]
    v_cvt_pk_bf16_f32 v13, v68, v69
    ds_write_b32 v17, v13 offset:3808
    v_pk_mul_f32 v[70:71], v[50:51], v[44:45] op_sel:[0,0] op_sel_hi:[0,1]
    v_pk_fma_f32 v[70:71], v[50:51], v[44:45], v[70:71] op_sel:[1,1,0] op_sel_hi:[1,0,1] neg_lo:[0,1,0]
    v_cvt_pk_bf16_f32 v14, v70, v71
    ds_write_b32 v17, v14 offset:4080
    s_waitcnt lgkmcnt(0)
    ds_read_b128 v[108:111], v18 offset:0
    ds_read_b128 v[112:115], v18 offset:64
    ds_read_b128 v[116:119], v18 offset:128
    ds_read_b128 v[120:123], v18 offset:192
    v_pk_mul_f32 v[54:55], v[52:53], v[46:47] op_sel:[0,0] op_sel_hi:[0,1]
    v_pk_fma_f32 v[54:55], v[52:53], v[46:47], v[54:55] op_sel:[1,1,0] op_sel_hi:[1,0,1] neg_lo:[0,1,0]
    v_cvt_pk_bf16_f32 v15, v52, v53
    ds_write_b32 v17, v15 offset:0
    v_pk_mul_f32 v[64:65], v[52:53], v[34:35] op_sel:[0,0] op_sel_hi:[0,1]
    v_pk_fma_f32 v[64:65], v[52:53], v[34:35], v[64:65] op_sel:[1,1,0] op_sel_hi:[1,0,1] neg_lo:[0,1,0]
    v_cvt_pk_bf16_f32 v12, v64, v65
    ds_write_b32 v17, v12 offset:272
    v_pk_mul_f32 v[66:67], v[52:53], v[38:39] op_sel:[0,0] op_sel_hi:[0,1]
    v_pk_fma_f32 v[66:67], v[52:53], v[38:39], v[66:67] op_sel:[1,1,0] op_sel_hi:[1,0,1] neg_lo:[0,1,0]
    v_cvt_pk_bf16_f32 v13, v66, v67
    ds_write_b32 v17, v13 offset:544
    v_pk_mul_f32 v[68:69], v[52:53], v[42:43] op_sel:[0,0] op_sel_hi:[0,1]
    v_pk_fma_f32 v[68:69], v[52:53], v[42:43], v[68:69] op_sel:[1,1,0] op_sel_hi:[1,0,1] neg_lo:[0,1,0]
    v_cvt_pk_bf16_f32 v14, v68, v69
    ds_write_b32 v17, v14 offset:816
    v_pk_mul_f32 v[56:57], v[54:55], v[46:47] op_sel:[0,0] op_sel_hi:[0,1]
    v_pk_fma_f32 v[56:57], v[54:55], v[46:47], v[56:57] op_sel:[1,1,0] op_sel_hi:[1,0,1] neg_lo:[0,1,0]
    v_cvt_pk_bf16_f32 v15, v54, v55
    ds_write_b32 v17, v15 offset:1088
    v_pk_mul_f32 v[64:65], v[54:55], v[34:35] op_sel:[0,0] op_sel_hi:[0,1]
    v_pk_fma_f32 v[64:65], v[54:55], v[34:35], v[64:65] op_sel:[1,1,0] op_sel_hi:[1,0,1] neg_lo:[0,1,0]
    v_cvt_pk_bf16_f32 v12, v64, v65
    ds_write_b32 v17, v12 offset:1360
    v_pk_mul_f32 v[66:67], v[54:55], v[38:39] op_sel:[0,0] op_sel_hi:[0,1]
    v_pk_fma_f32 v[66:67], v[54:55], v[38:39], v[66:67] op_sel:[1,1,0] op_sel_hi:[1,0,1] neg_lo:[0,1,0]
    v_cvt_pk_bf16_f32 v13, v66, v67
    ds_write_b32 v17, v13 offset:1632
    v_pk_mul_f32 v[68:69], v[54:55], v[42:43] op_sel:[0,0] op_sel_hi:[0,1]
    v_pk_fma_f32 v[68:69], v[54:55], v[42:43], v[68:69] op_sel:[1,1,0] op_sel_hi:[1,0,1] neg_lo:[0,1,0]
    v_cvt_pk_bf16_f32 v14, v68, v69
    ds_write_b32 v17, v14 offset:1904
    s_waitcnt lgkmcnt(8)
    v_mfma_f32_16x16x32_bf16 v[124:127], v[108:111], v[72:75], 0
    v_mfma_f32_16x16x32_bf16 v[124:127], v[112:115], v[76:79], v[124:127]
    v_mfma_f32_16x16x32_bf16 v[124:127], v[116:119], v[80:83], v[124:127]
    v_mfma_f32_16x16x32_bf16 v[124:127], v[120:123], v[84:87], v[124:127]
    v_pk_mul_f32 v[58:59], v[56:57], v[46:47] op_sel:[0,0] op_sel_hi:[0,1]
    v_pk_fma_f32 v[58:59], v[56:57], v[46:47], v[58:59] op_sel:[1,1,0] op_sel_hi:[1,0,1] neg_lo:[0,1,0]
    v_cvt_pk_bf16_f32 v15, v56, v57
    ds_write_b32 v17, v15 offset:2176
    v_pk_mul_f32 v[64:65], v[56:57], v[38:39] op_sel:[0,0] op_sel_hi:[0,1]
    v_pk_fma_f32 v[64:65], v[56:57], v[38:39], v[64:65] op_sel:[1,1,0] op_sel_hi:[1,0,1] neg_lo:[0,1,0]
    v_cvt_pk_bf16_f32 v12, v64, v65
    ds_write_b32 v17, v12 offset:2448
    v_pk_mul_f32 v[60:61], v[58:59], v[46:47] op_sel:[0,0] op_sel_hi:[0,1]
    v_pk_fma_f32 v[60:61], v[58:59], v[46:47], v[60:61] op_sel:[1,1,0] op_sel_hi:[1,0,1] neg_lo:[0,1,0]
    v_cvt_pk_bf16_f32 v13, v58, v59
    ds_write_b32 v17, v13 offset:2720
    v_pk_mul_f32 v[66:67], v[58:59], v[38:39] op_sel:[0,0] op_sel_hi:[0,1]
    v_pk_fma_f32 v[66:67], v[58:59], v[38:39], v[66:67] op_sel:[1,1,0] op_sel_hi:[1,0,1] neg_lo:[0,1,0]
    v_cvt_pk_bf16_f32 v14, v66, v67
    ds_write_b32 v17, v14 offset:2992
    v_pk_mul_f32 v[62:63], v[60:61], v[46:47] op_sel:[0,0] op_sel_hi:[0,1]
    v_pk_fma_f32 v[62:63], v[60:61], v[46:47], v[62:63] op_sel:[1,1,0] op_sel_hi:[1,0,1] neg_lo:[0,1,0]
    v_cvt_pk_bf16_f32 v15, v60, v61
    ds_write_b32 v17, v15 offset:3264
    v_pk_mul_f32 v[68:69], v[60:61], v[38:39] op_sel:[0,0] op_sel_hi:[0,1]
    v_pk_fma_f32 v[68:69], v[60:61], v[38:39], v[68:69] op_sel:[1,1,0] op_sel_hi:[1,0,1] neg_lo:[0,1,0]
    v_cvt_pk_bf16_f32 v12, v68, v69
    ds_write_b32 v17, v12 offset:3536
    v_pk_mul_f32 v[48:49], v[62:63], v[46:47] op_sel:[0,0] op_sel_hi:[0,1]
    v_pk_fma_f32 v[48:49], v[62:63], v[46:47], v[48:49] op_sel:[1,1,0] op_sel_hi:[1,0,1] neg_lo:[0,1,0]
    v_cvt_pk_bf16_f32 v13, v62, v63
    ds_write_b32 v17, v13 offset:3808
    v_pk_mul_f32 v[70:71], v[62:63], v[38:39] op_sel:[0,0] op_sel_hi:[0,1]
    v_pk_fma_f32 v[70:71], v[62:63], v[38:39], v[70:71] op_sel:[1,1,0] op_sel_hi:[1,0,1] neg_lo:[0,1,0]
    v_cvt_pk_bf16_f32 v14, v70, v71
    ds_write_b32 v17, v14 offset:4080
    s_waitcnt lgkmcnt(0)
    ds_read_b128 v[108:111], v18 offset:0
    ds_read_b128 v[112:115], v18 offset:64
    ds_read_b128 v[116:119], v18 offset:128
    ds_read_b128 v[120:123], v18 offset:192
    v_cvt_pk_bf16_f32 v15, v48, v49
    ds_write_b32 v17, v15 offset:0
    v_pk_mul_f32 v[50:51], v[48:49], v[46:47] op_sel:[0,0] op_sel_hi:[0,1]
    v_pk_fma_f32 v[50:51], v[48:49], v[46:47], v[50:51] op_sel:[1,1,0] op_sel_hi:[1,0,1] neg_lo:[0,1,0]
    v_cvt_pk_bf16_f32 v12, v50, v51
    ds_write_b32 v17, v12 offset:272
    v_pk_mul_f32 v[52:53], v[50:51], v[46:47] op_sel:[0,0] op_sel_hi:[0,1]
    v_pk_fma_f32 v[52:53], v[50:51], v[46:47], v[52:53] op_sel:[1,1,0] op_sel_hi:[1,0,1] neg_lo:[0,1,0]
    v_cvt_pk_bf16_f32 v13, v52, v53
    ds_write_b32 v17, v13 offset:544
    v_pk_mul_f32 v[54:55], v[52:53], v[46:47] op_sel:[0,0] op_sel_hi:[0,1]
    v_pk_fma_f32 v[54:55], v[52:53], v[46:47], v[54:55] op_sel:[1,1,0] op_sel_hi:[1,0,1] neg_lo:[0,1,0]
    v_cvt_pk_bf16_f32 v14, v54, v55
    ds_write_b32 v17, v14 offset:816
    v_pk_mul_f32 v[56:57], v[54:55], v[46:47] op_sel:[0,0] op_sel_hi:[0,1]
    v_pk_fma_f32 v[56:57], v[54:55], v[46:47], v[56:57] op_sel:[1,1,0] op_sel_hi:[1,0,1] neg_lo:[0,1,0]
    v_cvt_pk_bf16_f32 v15, v56, v57
    ds_write_b32 v17, v15 offset:1088
    v_pk_mul_f32 v[58:59], v[56:57], v[46:47] op_sel:[0,0] op_sel_hi:[0,1]
    v_pk_fma_f32 v[58:59], v[56:57], v[46:47], v[58:59] op_sel:[1,1,0] op_sel_hi:[1,0,1] neg_lo:[0,1,0]
    v_cvt_pk_bf16_f32 v12, v58, v59
    ds_write_b32 v17, v12 offset:1360
    v_pk_mul_f32 v[60:61], v[58:59], v[46:47] op_sel:[0,0] op_sel_hi:[0,1]
    v_pk_fma_f32 v[60:61], v[58:59], v[46:47], v[60:61] op_sel:[1,1,0] op_sel_hi:[1,0,1] neg_lo:[0,1,0]
    v_cvt_pk_bf16_f32 v13, v60, v61
    ds_write_b32 v17, v13 offset:1632
    v_pk_mul_f32 v[62:63], v[60:61], v[46:47] op_sel:[0,0] op_sel_hi:[0,1]
    v_pk_fma_f32 v[62:63], v[60:61], v[46:47], v[62:63] op_sel:[1,1,0] op_sel_hi:[1,0,1] neg_lo:[0,1,0]
    v_cvt_pk_bf16_f32 v14, v62, v63
    ds_write_b32 v17, v14 offset:1904
    v_pk_mul_f32 v[48:49], v[62:63], v[46:47] op_sel:[0,0] op_sel_hi:[0,1]
    v_pk_fma_f32 v[48:49], v[62:63], v[46:47], v[48:49] op_sel:[1,1,0] op_sel_hi:[1,0,1] neg_lo:[0,1,0]
    v_cvt_pk_bf16_f32 v15, v48, v49
    ds_write_b32 v17, v15 offset:2176
    s_waitcnt lgkmcnt(9)
    v_mfma_f32_16x16x32_bf16 v[128:131], v[108:111], v[72:75], 0
    v_mfma_f32_16x16x32_bf16 v[128:131], v[112:115], v[76:79], v[128:131]
    v_mfma_f32_16x16x32_bf16 v[128:131], v[116:119], v[80:83], v[128:131]
    v_mfma_f32_16x16x32_bf16 v[128:131], v[120:123], v[84:87], v[128:131]
    s_waitcnt lgkmcnt(0)
    ds_read_b128 v[108:111], v18 offset:0
    ds_read_b128 v[112:115], v18 offset:64
    ds_read_b128 v[116:119], v18 offset:128
    ds_read_b128 v[120:123], v18 offset:192
    s_waitcnt lgkmcnt(0)
    v_mfma_f32_16x16x32_bf16 v[132:135], v[108:111], v[72:75], 0
    v_mfma_f32_16x16x32_bf16 v[132:135], v[112:115], v[76:79], v[132:135]
    v_mfma_f32_16x16x32_bf16 v[132:135], v[116:119], v[80:83], v[132:135]
    v_mfma_f32_16x16x32_bf16 v[132:135], v[120:123], v[84:87], v[132:135]
    v_mul_u32_u24 v19, 4352, v2
    v_lshl_add_u32 v19, v1, 4, v19
    v_add_u32 v19, 0, v19
    ds_write_b128 v19, v[124:127]
    ds_write_b128 v19, v[128:131] offset:1024
    v_readfirstlane_b32 s38, v2
    v_lshlrev_b32 v20, 4, v1
    v_lshl_add_u32 v20, v2, 10, v20
    v_add_u32 v20, 0, v20
    s_nop 4
    ds_write_b128 v19, v[132:135] offset:2048
    s_waitcnt lgkmcnt(0)
    s_barrier
    s_cmp_eq_u32 s38, 3
    s_cbranch_scc1 Lkgte_1005
    ds_read_b128 v[108:111], v20 offset:0
    ds_read_b128 v[112:115], v20 offset:4352
    ds_read_b128 v[116:119], v20 offset:8704
    ds_read_b128 v[120:123], v20 offset:13056
    s_waitcnt lgkmcnt(2)
    v_pk_add_f32 v[108:109], v[108:109], v[112:113]
    v_pk_add_f32 v[110:111], v[110:111], v[114:115]
    s_waitcnt lgkmcnt(0)
    v_pk_add_f32 v[116:117], v[116:117], v[120:121]
    v_pk_add_f32 v[118:119], v[118:119], v[122:123]
    v_pk_add_f32 v[108:109], v[108:109], v[116:117]
    v_pk_add_f32 v[110:111], v[110:111], v[118:119]
    s_cmp_eq_u32 s38, 1
    s_cbranch_scc1 Lkgt1_1003
    s_cmp_eq_u32 s38, 2
    s_cbranch_scc1 Lkgt2_1004
    ds_write_b32 v90, v108 offset:0
    ds_write_b32 v90, v109 offset:4
    ds_write_b32 v90, v110 offset:8
    ds_write_b32 v90, v111 offset:12
    s_branch Lkgte_1005
Lkgt1_1003:
    ds_write_b32 v91, v108
    ds_write_b32 v91, v109 offset:4
    ds_write_b32 v92, v110
    ds_write_b32 v92, v111 offset:4
    s_branch Lkgte_1005
Lkgt2_1004:
    ds_write_b32 v93, v108
    ds_write_b32 v94, v109
    ds_write_b32 v94, v110 offset:64
    ds_write_b32 v94, v111 offset:128
Lkgte_1005:
    s_waitcnt lgkmcnt(0)
    s_barrier
    ds_read_b32 v108, v100
    ds_read_b32 v109, v101
    ds_read_b32 v110, v102
    ds_read_b32 v111, v103
    ds_read_b32 v112, v104
    ds_read_b32 v113, v105
    ds_read_b32 v114, v106
    ds_read_b32 v115, v107
    v_cmp_eq_u32 vcc, 0, v0
    v_mov_b32 v8, s37
    s_nop 0
    v_cndmask_b32 v8, 0, v8, vcc
    s_lshl_b32 s18, s48, 12
    v_lshlrev_b32 v9, 4, v0
    v_add_u32 v9, s18, v9
    s_waitcnt lgkmcnt(0)
    v_add_f32 v108, v108, v8
    v_cvt_pk_bf16_f32 v108, v108, v109
    v_cvt_pk_bf16_f32 v109, v110, v111
    v_cvt_pk_bf16_f32 v110, v112, v113
    v_cvt_pk_bf16_f32 v111, v114, v115
    s_waitcnt vmcnt(0)
    buffer_store_dwordx4 v[108:111], v9, s[40:43], 0 offen sc1

    s_bitcmp1_b32 s48, 0
    s_cbranch_scc1 Lkgend_1006
    s_add_u32 s48, s48, 1
    v_mov_b32 v4, v140
    v_mov_b32 v5, v141
    v_mov_b32 v6, v142
    v_mov_b32 v7, v143
    s_branch Lkgloop_1001
Lkgend_1006:

    s_endpgm
L0_lnA:
    s_sub_u32 s48, s2, 224
    s_branch L0_lnB
L0_ln:
    s_cmp_ge_u32 s2, 512
    s_cbranch_scc1 L0_end
    s_sub_u32 s48, s2, 448
L0_lnB:

    s_cmp_eq_u32 s48, 56
    s_cbranch_scc0 L0_ln2
    s_load_dwordx2 s[4:5], s[0:1], 104
    v_cmp_gt_u32 vcc, 224, v0
    s_and_saveexec_b64 s[8:9], vcc
    v_lshlrev_b32 v1, 2, v0
    v_add_u32 v1, 17893376, v1
    v_mov_b32 v2, 0
    s_waitcnt lgkmcnt(0)
    global_store_dword v1, v2, s[4:5] sc1
    s_mov_b64 exec, s[8:9]

L0_ln2:
    s_cmp_ge_u32 s48, 56
    s_cbranch_scc1 Llnwr1_1007
    s_load_dwordx2 s[52:53], s[0:1], 64
    s_load_dwordx2 s[54:55], s[0:1], 80
    s_load_dwordx2 s[56:57], s[0:1], 104
    v_and_b32 v129, 63, v0
    v_lshrrev_b32 v130, 6, v0
    s_nop 0
    v_readfirstlane_b32 s58, v130
    s_nop 3
    s_lshl_b32 s59, s48, 2
    s_add_u32 s59, s59, s58
    s_waitcnt lgkmcnt(0)

    s_add_u32 s59, s59, 224
    s_cmp_ge_u32 s59, 224
    s_cbranch_scc1 Lwr_w2_1507

    s_mov_b32 s60, s52
    s_mov_b32 s61, s53
    s_mov_b32 s62, 1605632
    s_mov_b32 s63, 0x00020000
    s_add_u32 s64, s56, 7340032
    s_addc_u32 s65, s57, 0
    s_mov_b32 s66, 1605632
    s_mov_b32 s67, 0x00020000
    s_lshr_b32 s68, s59, 3
    s_and_b32 s69, s59, 7
    s_mov_b32 s70, 3584
    s_mul_i32 s71, s68, 57344
    s_mul_i32 s72, s69, 448
    s_add_u32 s71, s71, s72
    s_mul_i32 s73, s69, 196
    s_add_u32 s73, s73, s68
    s_lshl_b32 s73, s73, 10
    s_mov_b32 s74, 28672
    s_mov_b32 s75, 8
    s_mov_b32 s76, 4
    s_branch Lwr_go_1508
Lwr_w2_1507:

    s_mov_b32 s60, s54
    s_mov_b32 s61, s55
    s_mov_b32 s62, 1605632
    s_mov_b32 s63, 0x00020000
    s_add_u32 s64, s56, 8945664
    s_addc_u32 s65, s57, 0
    s_mov_b32 s66, 1605632
    s_mov_b32 s67, 0x00020000
    s_sub_u32 s59, s59, 224
    s_lshr_b32 s68, s59, 1
    s_and_b32 s69, s59, 1
    s_mov_b32 s70, 896
    s_mul_i32 s71, s68, 14336
    s_mul_i32 s72, s69, 448
    s_add_u32 s71, s71, s72
    s_mul_i32 s73, s69, 784
    s_add_u32 s73, s73, s68
    s_lshl_b32 s73, s73, 10
    s_mov_b32 s74, 114688
    s_mov_b32 s75, 4
    s_mov_b32 s76, 8
Lwr_go_1508:

    v_lshrrev_b32 v131, 2, v129
    v_and_b32 v132, 3, v129
    v_mul_lo_u32 v133, s70, v131
    v_lshl_add_u32 v133, v132, 4, v133

    buffer_load_dwordx4 v[136:139], v133, s[60:63], s71 offen offset:0
    buffer_load_dwordx4 v[140:143], v133, s[60:63], s71 offen offset:64
    buffer_load_dwordx4 v[144:147], v133, s[60:63], s71 offen offset:128
    buffer_load_dwordx4 v[148:151], v133, s[60:63], s71 offen offset:192
    buffer_load_dwordx4 v[152:155], v133, s[60:63], s71 offen offset:256
    buffer_load_dwordx4 v[156:159], v133, s[60:63], s71 offen offset:320
    buffer_load_dwordx4 v[160:163], v133, s[60:63], s71 offen offset:384
    s_load_dwordx2 s[4:5], s[0:1], 0
    s_load_dwordx2 s[6:7], s[0:1], 104
    v_and_b32 v1, 63, v0
    v_lshrrev_b32 v2, 6, v0
    v_and_b32 v3, 31, v1
    v_lshrrev_b32 v4, 5, v1
    v_readfirstlane_b32 s8, v2
    s_mul_i32 s9, s48, 28672
    v_mul_u32_u24 v5, 896, v3
    v_lshl_add_u32 v5, v4, 4, v5
    s_mul_i32 s10, s8, 224
    s_add_u32 s9, s9, s10
    s_waitcnt lgkmcnt(0)

    s_mov_b32 s12, s4
    s_mov_b32 s13, s5
    s_mov_b32 s14, 1835008
    s_mov_b32 s15, 0x00020000
    s_add_u32 s16, s6, 5505024
    s_addc_u32 s17, s7, 0
    s_mov_b32 s18, 1835008
    s_mov_b32 s19, 0x00020000
    s_add_u32 s20, s6, 1835008
    s_addc_u32 s21, s7, 0
    s_mov_b32 s22, 1835008
    s_mov_b32 s23, 0x00020000
    buffer_load_dwordx4 v[8:11], v5, s[12:15], s9 offen offset:0
    buffer_load_dwordx4 v[12:15], v5, s[12:15], s9 offen offset:32
    buffer_load_dwordx4 v[16:19], v5, s[12:15], s9 offen offset:64
    buffer_load_dwordx4 v[20:23], v5, s[12:15], s9 offen offset:96
    buffer_load_dwordx4 v[24:27], v5, s[12:15], s9 offen offset:128
    buffer_load_dwordx4 v[28:31], v5, s[12:15], s9 offen offset:160
    buffer_load_dwordx4 v[32:35], v5, s[12:15], s9 offen offset:192
    v_mov_b32 v36, 0
    v_mov_b32 v37, 0
    v_mov_b32 v38, 0
    v_mov_b32 v39, 0
    s_waitcnt vmcnt(6)
    v_lshlrev_b32 v40, 16, v8
    v_and_b32 v41, 0xffff0000, v8
    v_add_f32 v36, v36, v40
    v_add_f32 v37, v37, v41
    v_fmac_f32 v38, v40, v40
    v_fmac_f32 v39, v41, v41
    v_lshlrev_b32 v42, 16, v9
    v_and_b32 v43, 0xffff0000, v9
    v_add_f32 v36, v36, v42
    v_add_f32 v37, v37, v43
    v_fmac_f32 v38, v42, v42
    v_fmac_f32 v39, v43, v43
    v_lshlrev_b32 v44, 16, v10
    v_and_b32 v45, 0xffff0000, v10
    v_add_f32 v36, v36, v44
    v_add_f32 v37, v37, v45
    v_fmac_f32 v38, v44, v44
    v_fmac_f32 v39, v45, v45
    v_lshlrev_b32 v46, 16, v11
    v_and_b32 v47, 0xffff0000, v11
    v_add_f32 v36, v36, v46
    v_add_f32 v37, v37, v47
    v_fmac_f32 v38, v46, v46
    v_fmac_f32 v39, v47, v47
    s_waitcnt vmcnt(5)
    v_lshlrev_b32 v48, 16, v12
    v_and_b32 v49, 0xffff0000, v12
    v_add_f32 v36, v36, v48
    v_add_f32 v37, v37, v49
    v_fmac_f32 v38, v48, v48
    v_fmac_f32 v39, v49, v49
    v_lshlrev_b32 v50, 16, v13
    v_and_b32 v51, 0xffff0000, v13
    v_add_f32 v36, v36, v50
    v_add_f32 v37, v37, v51
    v_fmac_f32 v38, v50, v50
    v_fmac_f32 v39, v51, v51
    v_lshlrev_b32 v52, 16, v14
    v_and_b32 v53, 0xffff0000, v14
    v_add_f32 v36, v36, v52
    v_add_f32 v37, v37, v53
    v_fmac_f32 v38, v52, v52
    v_fmac_f32 v39, v53, v53
    v_lshlrev_b32 v54, 16, v15
    v_and_b32 v55, 0xffff0000, v15
    v_add_f32 v36, v36, v54
    v_add_f32 v37, v37, v55
    v_fmac_f32 v38, v54, v54
    v_fmac_f32 v39, v55, v55
    s_waitcnt vmcnt(4)
    v_lshlrev_b32 v56, 16, v16
    v_and_b32 v57, 0xffff0000, v16
    v_add_f32 v36, v36, v56
    v_add_f32 v37, v37, v57
    v_fmac_f32 v38, v56, v56
    v_fmac_f32 v39, v57, v57
    v_lshlrev_b32 v58, 16, v17
    v_and_b32 v59, 0xffff0000, v17
    v_add_f32 v36, v36, v58
    v_add_f32 v37, v37, v59
    v_fmac_f32 v38, v58, v58
    v_fmac_f32 v39, v59, v59
    v_lshlrev_b32 v60, 16, v18
    v_and_b32 v61, 0xffff0000, v18
    v_add_f32 v36, v36, v60
    v_add_f32 v37, v37, v61
    v_fmac_f32 v38, v60, v60
    v_fmac_f32 v39, v61, v61
    v_lshlrev_b32 v62, 16, v19
    v_and_b32 v63, 0xffff0000, v19
    v_add_f32 v36, v36, v62
    v_add_f32 v37, v37, v63
    v_fmac_f32 v38, v62, v62
    v_fmac_f32 v39, v63, v63
    s_waitcnt vmcnt(3)
    v_lshlrev_b32 v64, 16, v20
    v_and_b32 v65, 0xffff0000, v20
    v_add_f32 v36, v36, v64
    v_add_f32 v37, v37, v65
    v_fmac_f32 v38, v64, v64
    v_fmac_f32 v39, v65, v65
    v_lshlrev_b32 v66, 16, v21
    v_and_b32 v67, 0xffff0000, v21
    v_add_f32 v36, v36, v66
    v_add_f32 v37, v37, v67
    v_fmac_f32 v38, v66, v66
    v_fmac_f32 v39, v67, v67
    v_lshlrev_b32 v68, 16, v22
    v_and_b32 v69, 0xffff0000, v22
    v_add_f32 v36, v36, v68
    v_add_f32 v37, v37, v69
    v_fmac_f32 v38, v68, v68
    v_fmac_f32 v39, v69, v69
    v_lshlrev_b32 v70, 16, v23
    v_and_b32 v71, 0xffff0000, v23
    v_add_f32 v36, v36, v70
    v_add_f32 v37, v37, v71
    v_fmac_f32 v38, v70, v70
    v_fmac_f32 v39, v71, v71
    s_waitcnt vmcnt(2)
    v_lshlrev_b32 v72, 16, v24
    v_and_b32 v73, 0xffff0000, v24
    v_add_f32 v36, v36, v72
    v_add_f32 v37, v37, v73
    v_fmac_f32 v38, v72, v72
    v_fmac_f32 v39, v73, v73
    v_lshlrev_b32 v74, 16, v25
    v_and_b32 v75, 0xffff0000, v25
    v_add_f32 v36, v36, v74
    v_add_f32 v37, v37, v75
    v_fmac_f32 v38, v74, v74
    v_fmac_f32 v39, v75, v75
    v_lshlrev_b32 v76, 16, v26
    v_and_b32 v77, 0xffff0000, v26
    v_add_f32 v36, v36, v76
    v_add_f32 v37, v37, v77
    v_fmac_f32 v38, v76, v76
    v_fmac_f32 v39, v77, v77
    v_lshlrev_b32 v78, 16, v27
    v_and_b32 v79, 0xffff0000, v27
    v_add_f32 v36, v36, v78
    v_add_f32 v37, v37, v79
    v_fmac_f32 v38, v78, v78
    v_fmac_f32 v39, v79, v79
    s_waitcnt vmcnt(1)
    v_lshlrev_b32 v80, 16, v28
    v_and_b32 v81, 0xffff0000, v28
    v_add_f32 v36, v36, v80
    v_add_f32 v37, v37, v81
    v_fmac_f32 v38, v80, v80
    v_fmac_f32 v39, v81, v81
    v_lshlrev_b32 v82, 16, v29
    v_and_b32 v83, 0xffff0000, v29
    v_add_f32 v36, v36, v82
    v_add_f32 v37, v37, v83
    v_fmac_f32 v38, v82, v82
    v_fmac_f32 v39, v83, v83
    v_lshlrev_b32 v84, 16, v30
    v_and_b32 v85, 0xffff0000, v30
    v_add_f32 v36, v36, v84
    v_add_f32 v37, v37, v85
    v_fmac_f32 v38, v84, v84
    v_fmac_f32 v39, v85, v85
    v_lshlrev_b32 v86, 16, v31
    v_and_b32 v87, 0xffff0000, v31
    v_add_f32 v36, v36, v86
    v_add_f32 v37, v37, v87
    v_fmac_f32 v38, v86, v86
    v_fmac_f32 v39, v87, v87
    s_waitcnt vmcnt(0)
    v_lshlrev_b32 v88, 16, v32
    v_and_b32 v89, 0xffff0000, v32
    v_add_f32 v36, v36, v88
    v_add_f32 v37, v37, v89
    v_fmac_f32 v38, v88, v88
    v_fmac_f32 v39, v89, v89
    v_lshlrev_b32 v90, 16, v33
    v_and_b32 v91, 0xffff0000, v33
    v_add_f32 v36, v36, v90
    v_add_f32 v37, v37, v91
    v_fmac_f32 v38, v90, v90
    v_fmac_f32 v39, v91, v91
    v_lshlrev_b32 v92, 16, v34
    v_and_b32 v93, 0xffff0000, v34
    v_add_f32 v36, v36, v92
    v_add_f32 v37, v37, v93
    v_fmac_f32 v38, v92, v92
    v_fmac_f32 v39, v93, v93
    v_lshlrev_b32 v94, 16, v35
    v_and_b32 v95, 0xffff0000, v35
    v_add_f32 v36, v36, v94
    v_add_f32 v37, v37, v95
    v_fmac_f32 v38, v94, v94
    v_fmac_f32 v39, v95, v95
    v_add_f32 v36, v36, v37
    v_add_f32 v37, v38, v39
    v_lshlrev_b32 v6, 3, v1
    v_lshl_add_u32 v6, v2, 9, v6
    v_add_u32 v6, 28672, v6
    ds_write_b64 v6, v[36:37]
    s_waitcnt lgkmcnt(0)
    s_barrier
    v_lshlrev_b32 v6, 3, v3
    v_add_u32 v6, 28672, v6

    ds_read_b64 v[8:9], v6 offset:0
    ds_read_b64 v[10:11], v6 offset:256
    ds_read_b64 v[12:13], v6 offset:512
    ds_read_b64 v[14:15], v6 offset:768
    ds_read_b64 v[16:17], v6 offset:1024
    ds_read_b64 v[18:19], v6 offset:1280
    ds_read_b64 v[20:21], v6 offset:1536
    ds_read_b64 v[22:23], v6 offset:1792
    s_waitcnt lgkmcnt(0)
    v_pk_add_f32 v[8:9], v[8:9], v[10:11]
    v_pk_add_f32 v[12:13], v[12:13], v[14:15]
    v_pk_add_f32 v[16:17], v[16:17], v[18:19]
    v_pk_add_f32 v[20:21], v[20:21], v[22:23]
    v_pk_add_f32 v[8:9], v[8:9], v[12:13]
    v_pk_add_f32 v[16:17], v[16:17], v[20:21]
    v_pk_add_f32 v[8:9], v[8:9], v[16:17]
    s_mov_b32 s24, 0x3b124925
    v_mul_f32 v8, s24, v8
    v_mul_f32 v9, s24, v9
    v_fma_f32 v9, -v8, v8, v9
    v_max_f32 v9, 0, v9
    v_cvt_pk_bf16_f32 v10, v8, v9
    v_and_b32 v11, 0xffff0000, v10
    v_lshlrev_b32 v10, 16, v10
    v_add_f32 v11, 0x3727c5ac, v11
    v_cvt_pk_bf16_f32 v11, v11, v11
    v_and_b32 v11, 0xffff0000, v11
    v_sqrt_f32 v11, v11
    s_nop 0
    v_cvt_pk_bf16_f32 v11, v11, v11
    v_and_b32 v11, 0xffff0000, v11
    v_rcp_f32 v11, v11
    s_nop 0
    v_mul_f32 v12, v10, v11

    v_mul_u32_u24 v13, 7168, v2
    v_mul_u32_u24 v15, 224, v3
    v_add_u32 v13, v13, v15
    v_lshl_add_u32 v13, v4, 4, v13
    v_add_u32 v13, 0, v13
    v_lshlrev_b32 v14, 4, v1
    s_mul_i32 s25, s48, 28
    s_mul_i32 s26, s8, 7
    s_add_u32 s25, s25, s26
    s_lshl_b32 s25, s25, 10

    v_fma_f32 v40, v40, v11, -v12
    v_fma_f32 v41, v41, v11, -v12
    v_cvt_pk_bf16_f32 v96, v40, v41
    v_fma_f32 v42, v42, v11, -v12
    v_fma_f32 v43, v43, v11, -v12
    v_cvt_pk_bf16_f32 v97, v42, v43
    v_fma_f32 v44, v44, v11, -v12
    v_fma_f32 v45, v45, v11, -v12
    v_cvt_pk_bf16_f32 v98, v44, v45
    v_fma_f32 v46, v46, v11, -v12
    v_fma_f32 v47, v47, v11, -v12
    v_cvt_pk_bf16_f32 v99, v46, v47
    ds_write_b128 v13, v[96:99] offset:0
    v_fma_f32 v48, v48, v11, -v12
    v_fma_f32 v49, v49, v11, -v12
    v_cvt_pk_bf16_f32 v100, v48, v49
    v_fma_f32 v50, v50, v11, -v12
    v_fma_f32 v51, v51, v11, -v12
    v_cvt_pk_bf16_f32 v101, v50, v51
    v_fma_f32 v52, v52, v11, -v12
    v_fma_f32 v53, v53, v11, -v12
    v_cvt_pk_bf16_f32 v102, v52, v53
    v_fma_f32 v54, v54, v11, -v12
    v_fma_f32 v55, v55, v11, -v12
    v_cvt_pk_bf16_f32 v103, v54, v55
    ds_write_b128 v13, v[100:103] offset:32
    v_fma_f32 v56, v56, v11, -v12
    v_fma_f32 v57, v57, v11, -v12
    v_cvt_pk_bf16_f32 v104, v56, v57
    v_fma_f32 v58, v58, v11, -v12
    v_fma_f32 v59, v59, v11, -v12
    v_cvt_pk_bf16_f32 v105, v58, v59
    v_fma_f32 v60, v60, v11, -v12
    v_fma_f32 v61, v61, v11, -v12
    v_cvt_pk_bf16_f32 v106, v60, v61
    v_fma_f32 v62, v62, v11, -v12
    v_fma_f32 v63, v63, v11, -v12
    v_cvt_pk_bf16_f32 v107, v62, v63
    ds_write_b128 v13, v[104:107] offset:64
    v_fma_f32 v64, v64, v11, -v12
    v_fma_f32 v65, v65, v11, -v12
    v_cvt_pk_bf16_f32 v108, v64, v65
    v_fma_f32 v66, v66, v11, -v12
    v_fma_f32 v67, v67, v11, -v12
    v_cvt_pk_bf16_f32 v109, v66, v67
    v_fma_f32 v68, v68, v11, -v12
    v_fma_f32 v69, v69, v11, -v12
    v_cvt_pk_bf16_f32 v110, v68, v69
    v_fma_f32 v70, v70, v11, -v12
    v_fma_f32 v71, v71, v11, -v12
    v_cvt_pk_bf16_f32 v111, v70, v71
    s_add_u32 s27, s25, 4096
    ds_write_b128 v13, v[108:111] offset:96
    v_fma_f32 v72, v72, v11, -v12
    v_fma_f32 v73, v73, v11, -v12
    v_cvt_pk_bf16_f32 v112, v72, v73
    v_fma_f32 v74, v74, v11, -v12
    v_fma_f32 v75, v75, v11, -v12
    v_cvt_pk_bf16_f32 v113, v74, v75
    v_fma_f32 v76, v76, v11, -v12
    v_fma_f32 v77, v77, v11, -v12
    v_cvt_pk_bf16_f32 v114, v76, v77
    v_fma_f32 v78, v78, v11, -v12
    v_fma_f32 v79, v79, v11, -v12
    v_cvt_pk_bf16_f32 v115, v78, v79
    ds_write_b128 v13, v[112:115] offset:128
    v_fma_f32 v80, v80, v11, -v12
    v_fma_f32 v81, v81, v11, -v12
    v_cvt_pk_bf16_f32 v116, v80, v81
    v_fma_f32 v82, v82, v11, -v12
    v_fma_f32 v83, v83, v11, -v12
    v_cvt_pk_bf16_f32 v117, v82, v83
    v_fma_f32 v84, v84, v11, -v12
    v_fma_f32 v85, v85, v11, -v12
    v_cvt_pk_bf16_f32 v118, v84, v85
    v_fma_f32 v86, v86, v11, -v12
    v_fma_f32 v87, v87, v11, -v12
    v_cvt_pk_bf16_f32 v119, v86, v87
    ds_write_b128 v13, v[116:119] offset:160
    v_fma_f32 v88, v88, v11, -v12
    v_fma_f32 v89, v89, v11, -v12
    v_cvt_pk_bf16_f32 v120, v88, v89
    v_fma_f32 v90, v90, v11, -v12
    v_fma_f32 v91, v91, v11, -v12
    v_cvt_pk_bf16_f32 v121, v90, v91
    v_fma_f32 v92, v92, v11, -v12
    v_fma_f32 v93, v93, v11, -v12
    v_cvt_pk_bf16_f32 v122, v92, v93
    v_fma_f32 v94, v94, v11, -v12
    v_fma_f32 v95, v95, v11, -v12
    v_cvt_pk_bf16_f32 v123, v94, v95
    ds_write_b128 v13, v[120:123] offset:192
    v_lshrrev_b32 v15, 4, v1
    v_and_b32 v16, 15, v1
    v_lshrrev_b32 v17, 2, v16
    v_and_b32 v18, 3, v16
    v_lshl_add_u32 v17, v15, 3, v17
    v_mul_u32_u24 v17, 224, v17
    v_lshl_add_u32 v17, v18, 3, v17
    v_mul_u32_u24 v19, 7168, v2
    v_add_u32 v17, v17, v19
    v_add_u32 v17, 0, v17
    v_lshlrev_b32 v20, 12, v16
    v_lshl_add_u32 v20, v15, 4, v20
    s_mul_i32 s28, s8, 458752
    s_lshl_b32 s29, s48, 6
    s_add_u32 s28, s28, s29
    s_waitcnt lgkmcnt(0)

    ds_read_b64_tr_b16 v[40:41], v17 offset:0
    ds_read_b64_tr_b16 v[42:43], v17 offset:896
    ds_read_b64_tr_b16 v[44:45], v17 offset:32
    ds_read_b64_tr_b16 v[46:47], v17 offset:928
    ds_read_b64_tr_b16 v[48:49], v17 offset:64
    ds_read_b64_tr_b16 v[50:51], v17 offset:960
    ds_read_b64_tr_b16 v[52:53], v17 offset:96
    ds_read_b64_tr_b16 v[54:55], v17 offset:992
    ds_read_b64_tr_b16 v[56:57], v17 offset:128
    ds_read_b64_tr_b16 v[58:59], v17 offset:1024
    ds_read_b64_tr_b16 v[60:61], v17 offset:160
    ds_read_b64_tr_b16 v[62:63], v17 offset:1056
    ds_read_b64_tr_b16 v[64:65], v17 offset:192
    ds_read_b64_tr_b16 v[66:67], v17 offset:1088
    s_waitcnt lgkmcnt(12)
    buffer_store_dwordx4 v[40:43], v20, s[20:23], s28 offen
    s_add_u32 s28, s28, 65536
    s_waitcnt lgkmcnt(10)
    buffer_store_dwordx4 v[44:47], v20, s[20:23], s28 offen
    s_add_u32 s28, s28, 65536
    s_waitcnt lgkmcnt(8)
    buffer_store_dwordx4 v[48:51], v20, s[20:23], s28 offen
    s_add_u32 s28, s28, 65536
    s_waitcnt lgkmcnt(6)
    buffer_store_dwordx4 v[52:55], v20, s[20:23], s28 offen
    s_add_u32 s28, s28, 65536
    s_waitcnt lgkmcnt(4)
    buffer_store_dwordx4 v[56:59], v20, s[20:23], s28 offen
    s_add_u32 s28, s28, 65536
    s_waitcnt lgkmcnt(2)
    buffer_store_dwordx4 v[60:63], v20, s[20:23], s28 offen
    s_add_u32 s28, s28, 65536
    s_waitcnt lgkmcnt(0)
    buffer_store_dwordx4 v[64:67], v20, s[20:23], s28 offen
    s_add_u32 s28, s28, 65536
    v_lshlrev_b32 v134, 10, v130
    v_add_u32 v134, 30720, v134
    v_lshl_add_u32 v135, v129, 4, v134
    v_lshrrev_b32 v168, 4, v129
    v_and_b32 v169, 15, v129
    v_lshrrev_b32 v170, 2, v169
    v_and_b32 v171, 3, v169
    v_and_b32 v172, 1, v168
    v_lshrrev_b32 v173, 1, v168
    v_mul_lo_u32 v173, s75, v173
    v_add_u32 v173, v173, v170
    v_lshl_add_u32 v174, v173, 6, v134
    v_lshl_add_u32 v174, v172, 5, v174
    v_lshl_add_u32 v174, v171, 3, v174
    s_lshl_b32 s76, s76, 6
    v_add_u32 v175, s76, v174
    v_lshlrev_b32 v176, 4, v129

    ds_write_b128 v135, v[136:139]
    ds_read_b64_tr_b16 v[180:181], v174
    ds_read_b64_tr_b16 v[182:183], v175
    s_waitcnt lgkmcnt(0)
    buffer_store_dwordx4 v[180:183], v176, s[64:67], s73 offen sc1
    s_add_u32 s73, s73, s74
    ds_write_b128 v135, v[140:143]
    ds_read_b64_tr_b16 v[184:185], v174
    ds_read_b64_tr_b16 v[186:187], v175
    s_waitcnt lgkmcnt(0)
    buffer_store_dwordx4 v[184:187], v176, s[64:67], s73 offen sc1
    s_add_u32 s73, s73, s74
    ds_write_b128 v135, v[144:147]
    ds_read_b64_tr_b16 v[180:181], v174
    ds_read_b64_tr_b16 v[182:183], v175
    s_waitcnt lgkmcnt(0)
    buffer_store_dwordx4 v[180:183], v176, s[64:67], s73 offen sc1
    s_add_u32 s73, s73, s74
    ds_write_b128 v135, v[148:151]
    ds_read_b64_tr_b16 v[184:185], v174
    ds_read_b64_tr_b16 v[186:187], v175
    s_waitcnt lgkmcnt(0)
    buffer_store_dwordx4 v[184:187], v176, s[64:67], s73 offen sc1
    s_add_u32 s73, s73, s74
    ds_write_b128 v135, v[152:155]
    ds_read_b64_tr_b16 v[180:181], v174
    ds_read_b64_tr_b16 v[182:183], v175
    s_waitcnt lgkmcnt(0)
    buffer_store_dwordx4 v[180:183], v176, s[64:67], s73 offen sc1
    s_add_u32 s73, s73, s74
    ds_write_b128 v135, v[156:159]
    ds_read_b64_tr_b16 v[184:185], v174
    ds_read_b64_tr_b16 v[186:187], v175
    s_waitcnt lgkmcnt(0)
    buffer_store_dwordx4 v[184:187], v176, s[64:67], s73 offen sc1
    s_add_u32 s73, s73, s74
    ds_write_b128 v135, v[160:163]
    ds_read_b64_tr_b16 v[180:181], v174
    ds_read_b64_tr_b16 v[182:183], v175
    s_waitcnt lgkmcnt(0)
    buffer_store_dwordx4 v[180:183], v176, s[64:67], s73 offen sc1
    s_add_u32 s73, s73, s74
    s_branch Llnwr2_1008
Llnwr1_1007:
    s_load_dwordx2 s[4:5], s[0:1], 0
    s_load_dwordx2 s[6:7], s[0:1], 104
    v_and_b32 v1, 63, v0
    v_lshrrev_b32 v2, 6, v0
    v_and_b32 v3, 31, v1
    v_lshrrev_b32 v4, 5, v1
    v_readfirstlane_b32 s8, v2
    s_mul_i32 s9, s48, 28672
    v_mul_u32_u24 v5, 896, v3
    v_lshl_add_u32 v5, v4, 4, v5
    s_mul_i32 s10, s8, 224
    s_add_u32 s9, s9, s10
    s_waitcnt lgkmcnt(0)

    s_mov_b32 s12, s4
    s_mov_b32 s13, s5
    s_mov_b32 s14, 1835008
    s_mov_b32 s15, 0x00020000
    s_add_u32 s16, s6, 5505024
    s_addc_u32 s17, s7, 0
    s_mov_b32 s18, 1835008
    s_mov_b32 s19, 0x00020000
    s_add_u32 s20, s6, 1835008
    s_addc_u32 s21, s7, 0
    s_mov_b32 s22, 1835008
    s_mov_b32 s23, 0x00020000
    buffer_load_dwordx4 v[8:11], v5, s[12:15], s9 offen offset:0
    buffer_load_dwordx4 v[12:15], v5, s[12:15], s9 offen offset:32
    buffer_load_dwordx4 v[16:19], v5, s[12:15], s9 offen offset:64
    buffer_load_dwordx4 v[20:23], v5, s[12:15], s9 offen offset:96
    buffer_load_dwordx4 v[24:27], v5, s[12:15], s9 offen offset:128
    buffer_load_dwordx4 v[28:31], v5, s[12:15], s9 offen offset:160
    buffer_load_dwordx4 v[32:35], v5, s[12:15], s9 offen offset:192
    v_mov_b32 v36, 0
    v_mov_b32 v37, 0
    v_mov_b32 v38, 0
    v_mov_b32 v39, 0
    s_waitcnt vmcnt(6)
    v_lshlrev_b32 v40, 16, v8
    v_and_b32 v41, 0xffff0000, v8
    v_add_f32 v36, v36, v40
    v_add_f32 v37, v37, v41
    v_fmac_f32 v38, v40, v40
    v_fmac_f32 v39, v41, v41
    v_lshlrev_b32 v42, 16, v9
    v_and_b32 v43, 0xffff0000, v9
    v_add_f32 v36, v36, v42
    v_add_f32 v37, v37, v43
    v_fmac_f32 v38, v42, v42
    v_fmac_f32 v39, v43, v43
    v_lshlrev_b32 v44, 16, v10
    v_and_b32 v45, 0xffff0000, v10
    v_add_f32 v36, v36, v44
    v_add_f32 v37, v37, v45
    v_fmac_f32 v38, v44, v44
    v_fmac_f32 v39, v45, v45
    v_lshlrev_b32 v46, 16, v11
    v_and_b32 v47, 0xffff0000, v11
    v_add_f32 v36, v36, v46
    v_add_f32 v37, v37, v47
    v_fmac_f32 v38, v46, v46
    v_fmac_f32 v39, v47, v47
    s_waitcnt vmcnt(5)
    v_lshlrev_b32 v48, 16, v12
    v_and_b32 v49, 0xffff0000, v12
    v_add_f32 v36, v36, v48
    v_add_f32 v37, v37, v49
    v_fmac_f32 v38, v48, v48
    v_fmac_f32 v39, v49, v49
    v_lshlrev_b32 v50, 16, v13
    v_and_b32 v51, 0xffff0000, v13
    v_add_f32 v36, v36, v50
    v_add_f32 v37, v37, v51
    v_fmac_f32 v38, v50, v50
    v_fmac_f32 v39, v51, v51
    v_lshlrev_b32 v52, 16, v14
    v_and_b32 v53, 0xffff0000, v14
    v_add_f32 v36, v36, v52
    v_add_f32 v37, v37, v53
    v_fmac_f32 v38, v52, v52
    v_fmac_f32 v39, v53, v53
    v_lshlrev_b32 v54, 16, v15
    v_and_b32 v55, 0xffff0000, v15
    v_add_f32 v36, v36, v54
    v_add_f32 v37, v37, v55
    v_fmac_f32 v38, v54, v54
    v_fmac_f32 v39, v55, v55
    s_waitcnt vmcnt(4)
    v_lshlrev_b32 v56, 16, v16
    v_and_b32 v57, 0xffff0000, v16
    v_add_f32 v36, v36, v56
    v_add_f32 v37, v37, v57
    v_fmac_f32 v38, v56, v56
    v_fmac_f32 v39, v57, v57
    v_lshlrev_b32 v58, 16, v17
    v_and_b32 v59, 0xffff0000, v17
    v_add_f32 v36, v36, v58
    v_add_f32 v37, v37, v59
    v_fmac_f32 v38, v58, v58
    v_fmac_f32 v39, v59, v59
    v_lshlrev_b32 v60, 16, v18
    v_and_b32 v61, 0xffff0000, v18
    v_add_f32 v36, v36, v60
    v_add_f32 v37, v37, v61
    v_fmac_f32 v38, v60, v60
    v_fmac_f32 v39, v61, v61
    v_lshlrev_b32 v62, 16, v19
    v_and_b32 v63, 0xffff0000, v19
    v_add_f32 v36, v36, v62
    v_add_f32 v37, v37, v63
    v_fmac_f32 v38, v62, v62
    v_fmac_f32 v39, v63, v63
    s_waitcnt vmcnt(3)
    v_lshlrev_b32 v64, 16, v20
    v_and_b32 v65, 0xffff0000, v20
    v_add_f32 v36, v36, v64
    v_add_f32 v37, v37, v65
    v_fmac_f32 v38, v64, v64
    v_fmac_f32 v39, v65, v65
    v_lshlrev_b32 v66, 16, v21
    v_and_b32 v67, 0xffff0000, v21
    v_add_f32 v36, v36, v66
    v_add_f32 v37, v37, v67
    v_fmac_f32 v38, v66, v66
    v_fmac_f32 v39, v67, v67
    v_lshlrev_b32 v68, 16, v22
    v_and_b32 v69, 0xffff0000, v22
    v_add_f32 v36, v36, v68
    v_add_f32 v37, v37, v69
    v_fmac_f32 v38, v68, v68
    v_fmac_f32 v39, v69, v69
    v_lshlrev_b32 v70, 16, v23
    v_and_b32 v71, 0xffff0000, v23
    v_add_f32 v36, v36, v70
    v_add_f32 v37, v37, v71
    v_fmac_f32 v38, v70, v70
    v_fmac_f32 v39, v71, v71
    s_waitcnt vmcnt(2)
    v_lshlrev_b32 v72, 16, v24
    v_and_b32 v73, 0xffff0000, v24
    v_add_f32 v36, v36, v72
    v_add_f32 v37, v37, v73
    v_fmac_f32 v38, v72, v72
    v_fmac_f32 v39, v73, v73
    v_lshlrev_b32 v74, 16, v25
    v_and_b32 v75, 0xffff0000, v25
    v_add_f32 v36, v36, v74
    v_add_f32 v37, v37, v75
    v_fmac_f32 v38, v74, v74
    v_fmac_f32 v39, v75, v75
    v_lshlrev_b32 v76, 16, v26
    v_and_b32 v77, 0xffff0000, v26
    v_add_f32 v36, v36, v76
    v_add_f32 v37, v37, v77
    v_fmac_f32 v38, v76, v76
    v_fmac_f32 v39, v77, v77
    v_lshlrev_b32 v78, 16, v27
    v_and_b32 v79, 0xffff0000, v27
    v_add_f32 v36, v36, v78
    v_add_f32 v37, v37, v79
    v_fmac_f32 v38, v78, v78
    v_fmac_f32 v39, v79, v79
    s_waitcnt vmcnt(1)
    v_lshlrev_b32 v80, 16, v28
    v_and_b32 v81, 0xffff0000, v28
    v_add_f32 v36, v36, v80
    v_add_f32 v37, v37, v81
    v_fmac_f32 v38, v80, v80
    v_fmac_f32 v39, v81, v81
    v_lshlrev_b32 v82, 16, v29
    v_and_b32 v83, 0xffff0000, v29
    v_add_f32 v36, v36, v82
    v_add_f32 v37, v37, v83
    v_fmac_f32 v38, v82, v82
    v_fmac_f32 v39, v83, v83
    v_lshlrev_b32 v84, 16, v30
    v_and_b32 v85, 0xffff0000, v30
    v_add_f32 v36, v36, v84
    v_add_f32 v37, v37, v85
    v_fmac_f32 v38, v84, v84
    v_fmac_f32 v39, v85, v85
    v_lshlrev_b32 v86, 16, v31
    v_and_b32 v87, 0xffff0000, v31
    v_add_f32 v36, v36, v86
    v_add_f32 v37, v37, v87
    v_fmac_f32 v38, v86, v86
    v_fmac_f32 v39, v87, v87
    s_waitcnt vmcnt(0)
    v_lshlrev_b32 v88, 16, v32
    v_and_b32 v89, 0xffff0000, v32
    v_add_f32 v36, v36, v88
    v_add_f32 v37, v37, v89
    v_fmac_f32 v38, v88, v88
    v_fmac_f32 v39, v89, v89
    v_lshlrev_b32 v90, 16, v33
    v_and_b32 v91, 0xffff0000, v33
    v_add_f32 v36, v36, v90
    v_add_f32 v37, v37, v91
    v_fmac_f32 v38, v90, v90
    v_fmac_f32 v39, v91, v91
    v_lshlrev_b32 v92, 16, v34
    v_and_b32 v93, 0xffff0000, v34
    v_add_f32 v36, v36, v92
    v_add_f32 v37, v37, v93
    v_fmac_f32 v38, v92, v92
    v_fmac_f32 v39, v93, v93
    v_lshlrev_b32 v94, 16, v35
    v_and_b32 v95, 0xffff0000, v35
    v_add_f32 v36, v36, v94
    v_add_f32 v37, v37, v95
    v_fmac_f32 v38, v94, v94
    v_fmac_f32 v39, v95, v95
    v_add_f32 v36, v36, v37
    v_add_f32 v37, v38, v39
    v_lshlrev_b32 v6, 3, v1
    v_lshl_add_u32 v6, v2, 9, v6
    v_add_u32 v6, 28672, v6
    ds_write_b64 v6, v[36:37]
    s_waitcnt lgkmcnt(0)
    s_barrier
    v_lshlrev_b32 v6, 3, v3
    v_add_u32 v6, 28672, v6

    ds_read_b64 v[8:9], v6 offset:0
    ds_read_b64 v[10:11], v6 offset:256
    ds_read_b64 v[12:13], v6 offset:512
    ds_read_b64 v[14:15], v6 offset:768
    ds_read_b64 v[16:17], v6 offset:1024
    ds_read_b64 v[18:19], v6 offset:1280
    ds_read_b64 v[20:21], v6 offset:1536
    ds_read_b64 v[22:23], v6 offset:1792
    s_waitcnt lgkmcnt(0)
    v_pk_add_f32 v[8:9], v[8:9], v[10:11]
    v_pk_add_f32 v[12:13], v[12:13], v[14:15]
    v_pk_add_f32 v[16:17], v[16:17], v[18:19]
    v_pk_add_f32 v[20:21], v[20:21], v[22:23]
    v_pk_add_f32 v[8:9], v[8:9], v[12:13]
    v_pk_add_f32 v[16:17], v[16:17], v[20:21]
    v_pk_add_f32 v[8:9], v[8:9], v[16:17]
    s_mov_b32 s24, 0x3b124925
    v_mul_f32 v8, s24, v8
    v_mul_f32 v9, s24, v9
    v_fma_f32 v9, -v8, v8, v9
    v_max_f32 v9, 0, v9
    v_cvt_pk_bf16_f32 v10, v8, v9
    v_and_b32 v11, 0xffff0000, v10
    v_lshlrev_b32 v10, 16, v10
    v_add_f32 v11, 0x3727c5ac, v11
    v_cvt_pk_bf16_f32 v11, v11, v11
    v_and_b32 v11, 0xffff0000, v11
    v_sqrt_f32 v11, v11
    s_nop 0
    v_cvt_pk_bf16_f32 v11, v11, v11
    v_and_b32 v11, 0xffff0000, v11
    v_rcp_f32 v11, v11
    s_nop 0
    v_mul_f32 v12, v10, v11

    v_mul_u32_u24 v13, 7168, v2
    v_mul_u32_u24 v15, 224, v3
    v_add_u32 v13, v13, v15
    v_lshl_add_u32 v13, v4, 4, v13
    v_add_u32 v13, 0, v13
    v_lshlrev_b32 v14, 4, v1
    s_mul_i32 s25, s48, 28
    s_mul_i32 s26, s8, 7
    s_add_u32 s25, s25, s26
    s_lshl_b32 s25, s25, 10

    v_fma_f32 v40, v40, v11, -v12
    v_fma_f32 v41, v41, v11, -v12
    v_cvt_pk_bf16_f32 v96, v40, v41
    v_fma_f32 v42, v42, v11, -v12
    v_fma_f32 v43, v43, v11, -v12
    v_cvt_pk_bf16_f32 v97, v42, v43
    v_fma_f32 v44, v44, v11, -v12
    v_fma_f32 v45, v45, v11, -v12
    v_cvt_pk_bf16_f32 v98, v44, v45
    v_fma_f32 v46, v46, v11, -v12
    v_fma_f32 v47, v47, v11, -v12
    v_cvt_pk_bf16_f32 v99, v46, v47
    ds_write_b128 v13, v[96:99] offset:0
    v_fma_f32 v48, v48, v11, -v12
    v_fma_f32 v49, v49, v11, -v12
    v_cvt_pk_bf16_f32 v100, v48, v49
    v_fma_f32 v50, v50, v11, -v12
    v_fma_f32 v51, v51, v11, -v12
    v_cvt_pk_bf16_f32 v101, v50, v51
    v_fma_f32 v52, v52, v11, -v12
    v_fma_f32 v53, v53, v11, -v12
    v_cvt_pk_bf16_f32 v102, v52, v53
    v_fma_f32 v54, v54, v11, -v12
    v_fma_f32 v55, v55, v11, -v12
    v_cvt_pk_bf16_f32 v103, v54, v55
    ds_write_b128 v13, v[100:103] offset:32
    v_fma_f32 v56, v56, v11, -v12
    v_fma_f32 v57, v57, v11, -v12
    v_cvt_pk_bf16_f32 v104, v56, v57
    v_fma_f32 v58, v58, v11, -v12
    v_fma_f32 v59, v59, v11, -v12
    v_cvt_pk_bf16_f32 v105, v58, v59
    v_fma_f32 v60, v60, v11, -v12
    v_fma_f32 v61, v61, v11, -v12
    v_cvt_pk_bf16_f32 v106, v60, v61
    v_fma_f32 v62, v62, v11, -v12
    v_fma_f32 v63, v63, v11, -v12
    v_cvt_pk_bf16_f32 v107, v62, v63
    ds_write_b128 v13, v[104:107] offset:64
    v_fma_f32 v64, v64, v11, -v12
    v_fma_f32 v65, v65, v11, -v12
    v_cvt_pk_bf16_f32 v108, v64, v65
    v_fma_f32 v66, v66, v11, -v12
    v_fma_f32 v67, v67, v11, -v12
    v_cvt_pk_bf16_f32 v109, v66, v67
    v_fma_f32 v68, v68, v11, -v12
    v_fma_f32 v69, v69, v11, -v12
    v_cvt_pk_bf16_f32 v110, v68, v69
    v_fma_f32 v70, v70, v11, -v12
    v_fma_f32 v71, v71, v11, -v12
    v_cvt_pk_bf16_f32 v111, v70, v71
    s_add_u32 s27, s25, 4096
    ds_write_b128 v13, v[108:111] offset:96
    v_fma_f32 v72, v72, v11, -v12
    v_fma_f32 v73, v73, v11, -v12
    v_cvt_pk_bf16_f32 v112, v72, v73
    v_fma_f32 v74, v74, v11, -v12
    v_fma_f32 v75, v75, v11, -v12
    v_cvt_pk_bf16_f32 v113, v74, v75
    v_fma_f32 v76, v76, v11, -v12
    v_fma_f32 v77, v77, v11, -v12
    v_cvt_pk_bf16_f32 v114, v76, v77
    v_fma_f32 v78, v78, v11, -v12
    v_fma_f32 v79, v79, v11, -v12
    v_cvt_pk_bf16_f32 v115, v78, v79
    ds_write_b128 v13, v[112:115] offset:128
    v_fma_f32 v80, v80, v11, -v12
    v_fma_f32 v81, v81, v11, -v12
    v_cvt_pk_bf16_f32 v116, v80, v81
    v_fma_f32 v82, v82, v11, -v12
    v_fma_f32 v83, v83, v11, -v12
    v_cvt_pk_bf16_f32 v117, v82, v83
    v_fma_f32 v84, v84, v11, -v12
    v_fma_f32 v85, v85, v11, -v12
    v_cvt_pk_bf16_f32 v118, v84, v85
    v_fma_f32 v86, v86, v11, -v12
    v_fma_f32 v87, v87, v11, -v12
    v_cvt_pk_bf16_f32 v119, v86, v87
    ds_write_b128 v13, v[116:119] offset:160
    v_fma_f32 v88, v88, v11, -v12
    v_fma_f32 v89, v89, v11, -v12
    v_cvt_pk_bf16_f32 v120, v88, v89
    v_fma_f32 v90, v90, v11, -v12
    v_fma_f32 v91, v91, v11, -v12
    v_cvt_pk_bf16_f32 v121, v90, v91
    v_fma_f32 v92, v92, v11, -v12
    v_fma_f32 v93, v93, v11, -v12
    v_cvt_pk_bf16_f32 v122, v92, v93
    v_fma_f32 v94, v94, v11, -v12
    v_fma_f32 v95, v95, v11, -v12
    v_cvt_pk_bf16_f32 v123, v94, v95
    ds_write_b128 v13, v[120:123] offset:192
    v_lshrrev_b32 v15, 4, v1
    v_and_b32 v16, 15, v1
    v_lshrrev_b32 v17, 2, v16
    v_and_b32 v18, 3, v16
    v_lshl_add_u32 v17, v15, 3, v17
    v_mul_u32_u24 v17, 224, v17
    v_lshl_add_u32 v17, v18, 3, v17
    v_mul_u32_u24 v19, 7168, v2
    v_add_u32 v17, v17, v19
    v_add_u32 v17, 0, v17
    v_lshlrev_b32 v20, 12, v16
    v_lshl_add_u32 v20, v15, 4, v20
    s_mul_i32 s28, s8, 458752
    s_lshl_b32 s29, s48, 6
    s_add_u32 s28, s28, s29
    s_waitcnt lgkmcnt(0)

    ds_read_b64_tr_b16 v[40:41], v17 offset:0
    ds_read_b64_tr_b16 v[42:43], v17 offset:896
    ds_read_b64_tr_b16 v[44:45], v17 offset:32
    ds_read_b64_tr_b16 v[46:47], v17 offset:928
    ds_read_b64_tr_b16 v[48:49], v17 offset:64
    ds_read_b64_tr_b16 v[50:51], v17 offset:960
    ds_read_b64_tr_b16 v[52:53], v17 offset:96
    ds_read_b64_tr_b16 v[54:55], v17 offset:992
    ds_read_b64_tr_b16 v[56:57], v17 offset:128
    ds_read_b64_tr_b16 v[58:59], v17 offset:1024
    ds_read_b64_tr_b16 v[60:61], v17 offset:160
    ds_read_b64_tr_b16 v[62:63], v17 offset:1056
    ds_read_b64_tr_b16 v[64:65], v17 offset:192
    ds_read_b64_tr_b16 v[66:67], v17 offset:1088
    s_waitcnt lgkmcnt(12)
    buffer_store_dwordx4 v[40:43], v20, s[20:23], s28 offen
    s_add_u32 s28, s28, 65536
    s_waitcnt lgkmcnt(10)
    buffer_store_dwordx4 v[44:47], v20, s[20:23], s28 offen
    s_add_u32 s28, s28, 65536
    s_waitcnt lgkmcnt(8)
    buffer_store_dwordx4 v[48:51], v20, s[20:23], s28 offen
    s_add_u32 s28, s28, 65536
    s_waitcnt lgkmcnt(6)
    buffer_store_dwordx4 v[52:55], v20, s[20:23], s28 offen
    s_add_u32 s28, s28, 65536
    s_waitcnt lgkmcnt(4)
    buffer_store_dwordx4 v[56:59], v20, s[20:23], s28 offen
    s_add_u32 s28, s28, 65536
    s_waitcnt lgkmcnt(2)
    buffer_store_dwordx4 v[60:63], v20, s[20:23], s28 offen
    s_add_u32 s28, s28, 65536
    s_waitcnt lgkmcnt(0)
    buffer_store_dwordx4 v[64:67], v20, s[20:23], s28 offen
    s_add_u32 s28, s28, 65536
Llnwr2_1008:
    s_endpgm
L0_end:
    s_endpgm
.globl p1_kernel
.p2align 8
.type p1_kernel,@function
p1_kernel:
    s_cmp_lt_u32 s2, 32
    s_cbranch_scc0 Lpf_skip1

    s_getpc_b64 s[60:61]
Lpf_here1:

    s_mov_b32 s62, Lcode_end-Lpf_here1
    v_lshlrev_b32 v4, 7, v0

    v_cmp_gt_u32 vcc, s62, v4
    s_and_saveexec_b64 s[64:65], vcc
    s_cbranch_execz Lpf_e1_0
    v_mov_b32 v3, s61
    v_add_co_u32 v2, vcc, s60, v4
    v_addc_co_u32 v3, vcc, 0, v3, vcc
    global_load_dword v247, v[2:3], off
Lpf_e1_0:
    s_mov_b64 exec, s[64:65]
    v_add_u32 v4, 32768, v4

Lpf_skip1:
    s_cmp_ge_u32 s2, 448
    s_cbranch_scc1 L1_end
    s_cmp_ge_u32 s2, 224
    s_cbranch_scc1 L1_g2
    s_mov_b32 s48, s2

    s_setprio 0
    s_load_dwordx2 s[4:5], s[0:1], 104
    v_and_b32 v1, 63, v0
    v_lshrrev_b32 v2, 6, v0
    s_nop 0
    v_readfirstlane_b32 s6, v2
    s_nop 3
    s_lshr_b32 s7, s6, 1
    s_and_b32 s6, s6, 1
    s_lshl_b32 s8, s48, 1
    s_add_u32 s8, s8, s7
    s_lshl_b32 s9, s8, 12
    s_mul_i32 s10, s7, 21248
    s_add_u32 s10, s10, 0
    s_waitcnt lgkmcnt(0)

    s_add_u32 s12, s4, s9
    s_addc_u32 s13, s5, 0
    s_mov_b32 s14, 4096
    s_mov_b32 s15, 0x00020000
    s_add_u32 s16, s4, s9
    s_addc_u32 s17, s5, 0
    s_add_u32 s16, s16, 1835008
    s_addc_u32 s17, s17, 0
    s_mov_b32 s18, 4096
    s_mov_b32 s19, 0x00020000
    s_add_u32 s20, s4, s9
    s_addc_u32 s21, s5, 0
    s_add_u32 s20, s20, 3670016
    s_addc_u32 s21, s21, 0
    s_mov_b32 s22, 4096
    s_mov_b32 s23, 0x00020000
    s_lshl_b32 s11, s6, 6
    v_add_u32 v3, s11, v1
    v_lshlrev_b32 v4, 4, v3
    v_subrev_u32 v5, 8, v4
    buffer_load_dwordx4 v[8:11], v4, s[12:15], 0 offen
    buffer_load_dwordx2 v[12:13], v5, s[12:15], 0 offen
    buffer_load_dwordx4 v[16:19], v4, s[12:15], 0 offen offset:2048
    buffer_load_dwordx2 v[20:21], v4, s[12:15], 0 offen offset:2040
    buffer_load_dwordx4 v[24:27], v4, s[16:19], 0 offen
    buffer_load_dwordx4 v[28:31], v4, s[16:19], 0 offen offset:2048

    v_mov_b32 v32, 0
    v_mov_b32 v33, 0
    v_mov_b32 v34, 0
    v_mov_b32 v35, 0
    v_lshlrev_b32 v6, 4, v1
    v_add_u32 v6, s10, v6
    v_cmp_gt_u32 vcc, 32, v1
    s_and_saveexec_b64 s[24:25], vcc
    ds_write_b128 v6, v[32:35] offset:16640
    s_mov_b64 exec, s[24:25]
    v_lshrrev_b32 v7, 1, v1
    v_mul_u32_u24 v7, 4160, v7
    v_and_b32 v36, 1, v1
    v_lshl_add_u32 v7, v36, 4, v7
    v_add_u32 v7, s10, v7
    v_cmp_gt_u32 vcc, 8, v1
    s_and_saveexec_b64 s[24:25], vcc
    ds_write_b128 v7, v[32:35]
    s_mov_b64 exec, s[24:25]

    v_add_u32 v36, s10, v4
    v_add_u32 v37, 17152, v36
    v_add_u32 v36, 32, v36

    v_lshrrev_b32 v40, 4, v1
    v_and_b32 v41, 15, v1
    v_lshrrev_b32 v42, 2, v41
    v_and_b32 v43, 3, v41
    v_mul_u32_u24 v38, 4160, v42
    v_lshl_add_u32 v38, v43, 3, v38
    v_lshlrev_b32 v44, 4, v40
    v_sub_u32 v38, v38, v44
    v_add_u32 v38, 56, v38
    v_add_u32 v38, s10, v38
    v_lshlrev_b32 v39, 5, v41
    v_add_u32 v39, v39, v44
    v_add_u32 v39, 16672, v39
    v_add_u32 v39, s10, v39

    v_lshlrev_b32 v45, 5, v41
    v_lshl_add_u32 v45, v40, 3, v45

    v_and_b32 v61, 1, v40
    v_lshrrev_b32 v62, 1, v40
    v_lshlrev_b32 v60, 5, v41
    v_lshl_add_u32 v60, v61, 9, v60
    v_lshl_add_u32 v60, v62, 4, v60

    s_waitcnt vmcnt(4)
    v_alignbyte_b32 v46, v13, v12, 2
    v_alignbyte_b32 v47, v8, v13, 2
    v_alignbyte_b32 v48, v9, v8, 2
    v_alignbyte_b32 v49, v10, v9, 2
    v_alignbyte_b32 v50, v11, v10, 2
    ds_write_b128 v36, v[8:11] offset:0
    v_mov_b32 v52, v13
    v_mov_b32 v53, v8
    v_mov_b32 v54, v9
    v_mov_b32 v55, v10
    ds_write_b128 v36, v[52:55] offset:8320
    ds_write_b128 v36, v[46:49] offset:12480
    v_mov_b32 v56, v47
    v_mov_b32 v57, v48
    v_mov_b32 v58, v49
    v_mov_b32 v59, v50
    ds_write_b128 v36, v[56:59] offset:4160
    s_waitcnt vmcnt(2)
    v_alignbyte_b32 v46, v21, v20, 2
    v_alignbyte_b32 v47, v16, v21, 2
    v_alignbyte_b32 v48, v17, v16, 2
    v_alignbyte_b32 v49, v18, v17, 2
    v_alignbyte_b32 v50, v19, v18, 2
    ds_write_b128 v36, v[16:19] offset:2048
    v_mov_b32 v52, v21
    v_mov_b32 v53, v16
    v_mov_b32 v54, v17
    v_mov_b32 v55, v18
    ds_write_b128 v36, v[52:55] offset:10368
    ds_write_b128 v36, v[46:49] offset:14528
    v_mov_b32 v56, v47
    v_mov_b32 v57, v48
    v_mov_b32 v58, v49
    v_mov_b32 v59, v50
    ds_write_b128 v36, v[56:59] offset:6208
    s_waitcnt vmcnt(0)
    ds_write_b128 v37, v[24:27]
    ds_write_b128 v37, v[28:31] offset:2048
    s_waitcnt lgkmcnt(0)
    s_barrier
    s_setprio 0
    s_cmp_eq_u32 s6, 1
    s_cbranch_scc1 Lcv_p1_2001
    ds_read_b128 v[96:99], v39 offset:448
    ds_read_b128 v[128:131], v39 offset:1984
    ds_read_b128 v[160:163], v39 offset:2496
    ds_read_b128 v[192:195], v39 offset:4032
    ds_read_b64_tr_b16 v[224:225], v38 offset:8
    ds_read_b64_tr_b16 v[226:227], v38 offset:0
    ds_read_b128 v[100:103], v39 offset:384
    ds_read_b128 v[132:135], v39 offset:1920
    ds_read_b128 v[164:167], v39 offset:2432
    ds_read_b128 v[196:199], v39 offset:3968
    ds_read_b64_tr_b16 v[228:229], v38 offset:72
    ds_read_b64_tr_b16 v[230:231], v38 offset:64
    ds_read_b64_tr_b16 v[232:233], v38 offset:136
    ds_read_b64_tr_b16 v[234:235], v38 offset:128
    ds_read_b64_tr_b16 v[236:237], v38 offset:200
    ds_read_b64_tr_b16 v[238:239], v38 offset:192
    ds_read_b64_tr_b16 v[240:241], v38 offset:264
    ds_read_b64_tr_b16 v[242:243], v38 offset:256
    ds_read_b128 v[104:107], v39 offset:320
    ds_read_b128 v[136:139], v39 offset:1856
    ds_read_b128 v[168:171], v39 offset:2368
    ds_read_b128 v[200:203], v39 offset:3904
    ds_read_b64_tr_b16 v[244:245], v38 offset:328
    ds_read_b64_tr_b16 v[246:247], v38 offset:320
    s_waitcnt lgkmcnt(15)
    v_mfma_f32_16x16x32_bf16 v[64:67], v[224:227], v[96:99], 0
    v_mfma_f32_16x16x32_bf16 v[76:79], v[224:227], v[128:131], 0
    v_mfma_f32_16x16x32_bf16 v[80:83], v[224:227], v[160:163], 0
    v_mfma_f32_16x16x32_bf16 v[92:95], v[224:227], v[192:195], 0
    ds_read_b128 v[108:111], v39 offset:256
    ds_read_b128 v[140:143], v39 offset:1792
    ds_read_b128 v[172:175], v39 offset:2304
    ds_read_b128 v[204:207], v39 offset:3840
    ds_read_b64_tr_b16 v[224:225], v38 offset:392
    ds_read_b64_tr_b16 v[226:227], v38 offset:384
    s_waitcnt lgkmcnt(15)
    v_mfma_f32_16x16x32_bf16 v[64:67], v[228:231], v[100:103], v[64:67]
    v_mfma_f32_16x16x32_bf16 v[76:79], v[228:231], v[132:135], v[76:79]
    v_mfma_f32_16x16x32_bf16 v[80:83], v[228:231], v[164:167], v[80:83]
    v_mfma_f32_16x16x32_bf16 v[92:95], v[228:231], v[196:199], v[92:95]
    ds_read_b128 v[112:115], v39 offset:192
    ds_read_b128 v[144:147], v39 offset:1728
    ds_read_b128 v[176:179], v39 offset:2240
    ds_read_b128 v[208:211], v39 offset:3776
    ds_read_b64_tr_b16 v[228:229], v38 offset:456
    ds_read_b64_tr_b16 v[230:231], v38 offset:448
    s_waitcnt lgkmcnt(14)
    v_mfma_f32_16x16x32_bf16 v[64:67], v[232:235], v[104:107], v[64:67]
    v_mfma_f32_16x16x32_bf16 v[76:79], v[232:235], v[136:139], v[76:79]
    v_mfma_f32_16x16x32_bf16 v[80:83], v[232:235], v[168:171], v[80:83]
    v_mfma_f32_16x16x32_bf16 v[92:95], v[232:235], v[200:203], v[92:95]
    ds_read_b128 v[116:119], v39 offset:128
    ds_read_b128 v[148:151], v39 offset:1664
    ds_read_b128 v[180:183], v39 offset:2176
    ds_read_b128 v[212:215], v39 offset:3712
    ds_read_b64_tr_b16 v[232:233], v38 offset:520
    ds_read_b64_tr_b16 v[234:235], v38 offset:512
    s_waitcnt lgkmcnt(14)
    v_mfma_f32_16x16x32_bf16 v[64:67], v[236:239], v[108:111], v[64:67]
    v_mfma_f32_16x16x32_bf16 v[76:79], v[236:239], v[140:143], v[76:79]
    v_mfma_f32_16x16x32_bf16 v[80:83], v[236:239], v[172:175], v[80:83]
    v_mfma_f32_16x16x32_bf16 v[92:95], v[236:239], v[204:207], v[92:95]
    ds_read_b128 v[120:123], v39 offset:64
    ds_read_b128 v[152:155], v39 offset:1600
    ds_read_b128 v[184:187], v39 offset:2112
    ds_read_b128 v[216:219], v39 offset:3648
    ds_read_b64_tr_b16 v[236:237], v38 offset:584
    ds_read_b64_tr_b16 v[238:239], v38 offset:576
    s_waitcnt lgkmcnt(14)
    v_mfma_f32_16x16x32_bf16 v[64:67], v[240:243], v[112:115], v[64:67]
    v_mfma_f32_16x16x32_bf16 v[76:79], v[240:243], v[144:147], v[76:79]
    v_mfma_f32_16x16x32_bf16 v[80:83], v[240:243], v[176:179], v[80:83]
    v_mfma_f32_16x16x32_bf16 v[92:95], v[240:243], v[208:211], v[92:95]
    ds_read_b128 v[124:127], v39 offset:0
    ds_read_b128 v[156:159], v39 offset:1536
    ds_read_b128 v[188:191], v39 offset:2048
    ds_read_b128 v[220:223], v39 offset:3584
    ds_read_b64_tr_b16 v[240:241], v38 offset:648
    ds_read_b64_tr_b16 v[242:243], v38 offset:640
    s_waitcnt lgkmcnt(14)
    v_mfma_f32_16x16x32_bf16 v[64:67], v[244:247], v[116:119], v[64:67]
    v_mfma_f32_16x16x32_bf16 v[76:79], v[244:247], v[148:151], v[76:79]
    v_mfma_f32_16x16x32_bf16 v[80:83], v[244:247], v[180:183], v[80:83]
    v_mfma_f32_16x16x32_bf16 v[92:95], v[244:247], v[212:215], v[92:95]
    ds_read_b64_tr_b16 v[244:245], v38 offset:712
    ds_read_b64_tr_b16 v[246:247], v38 offset:704
    s_waitcnt lgkmcnt(10)
    v_mfma_f32_16x16x32_bf16 v[64:67], v[224:227], v[120:123], v[64:67]
    v_mfma_f32_16x16x32_bf16 v[76:79], v[224:227], v[152:155], v[76:79]
    v_mfma_f32_16x16x32_bf16 v[80:83], v[224:227], v[184:187], v[80:83]
    v_mfma_f32_16x16x32_bf16 v[92:95], v[224:227], v[216:219], v[92:95]
    ds_read_b64_tr_b16 v[224:225], v38 offset:776
    ds_read_b64_tr_b16 v[226:227], v38 offset:768
    s_waitcnt lgkmcnt(6)
    v_mfma_f32_16x16x32_bf16 v[64:67], v[228:231], v[124:127], v[64:67]
    v_mfma_f32_16x16x32_bf16 v[76:79], v[228:231], v[156:159], v[76:79]
    v_mfma_f32_16x16x32_bf16 v[80:83], v[228:231], v[188:191], v[80:83]
    v_mfma_f32_16x16x32_bf16 v[92:95], v[228:231], v[220:223], v[92:95]
    ds_read_b64_tr_b16 v[228:229], v38 offset:840
    ds_read_b64_tr_b16 v[230:231], v38 offset:832
    s_waitcnt lgkmcnt(15)
    v_mfma_f32_16x16x32_bf16 v[68:71], v[232:235], v[96:99], 0
    v_mfma_f32_16x16x32_bf16 v[80:83], v[232:235], v[128:131], v[80:83]
    v_mfma_f32_16x16x32_bf16 v[84:87], v[232:235], v[160:163], 0
    ds_read_b64_tr_b16 v[232:233], v38 offset:904
    ds_read_b64_tr_b16 v[234:235], v38 offset:896
    s_waitcnt lgkmcnt(14)
    v_mfma_f32_16x16x32_bf16 v[68:71], v[236:239], v[100:103], v[68:71]
    v_mfma_f32_16x16x32_bf16 v[80:83], v[236:239], v[132:135], v[80:83]
    v_mfma_f32_16x16x32_bf16 v[84:87], v[236:239], v[164:167], v[84:87]
    ds_read_b64_tr_b16 v[236:237], v38 offset:968
    ds_read_b64_tr_b16 v[238:239], v38 offset:960
    s_waitcnt lgkmcnt(10)
    v_mfma_f32_16x16x32_bf16 v[68:71], v[240:243], v[104:107], v[68:71]
    v_mfma_f32_16x16x32_bf16 v[80:83], v[240:243], v[136:139], v[80:83]
    v_mfma_f32_16x16x32_bf16 v[84:87], v[240:243], v[168:171], v[84:87]
    ds_read_b64_tr_b16 v[240:241], v38 offset:1032
    ds_read_b64_tr_b16 v[242:243], v38 offset:1024
    s_waitcnt lgkmcnt(10)
    v_mfma_f32_16x16x32_bf16 v[68:71], v[244:247], v[108:111], v[68:71]
    v_mfma_f32_16x16x32_bf16 v[80:83], v[244:247], v[140:143], v[80:83]
    v_mfma_f32_16x16x32_bf16 v[84:87], v[244:247], v[172:175], v[84:87]
    ds_read_b64_tr_b16 v[244:245], v38 offset:1096
    ds_read_b64_tr_b16 v[246:247], v38 offset:1088
    s_waitcnt lgkmcnt(10)
    v_mfma_f32_16x16x32_bf16 v[68:71], v[224:227], v[112:115], v[68:71]
    v_mfma_f32_16x16x32_bf16 v[80:83], v[224:227], v[144:147], v[80:83]
    v_mfma_f32_16x16x32_bf16 v[84:87], v[224:227], v[176:179], v[84:87]
    ds_read_b64_tr_b16 v[224:225], v38 offset:1160
    ds_read_b64_tr_b16 v[226:227], v38 offset:1152
    s_waitcnt lgkmcnt(10)
    v_mfma_f32_16x16x32_bf16 v[68:71], v[228:231], v[116:119], v[68:71]
    v_mfma_f32_16x16x32_bf16 v[80:83], v[228:231], v[148:151], v[80:83]
    v_mfma_f32_16x16x32_bf16 v[84:87], v[228:231], v[180:183], v[84:87]
    ds_read_b64_tr_b16 v[228:229], v38 offset:1224
    ds_read_b64_tr_b16 v[230:231], v38 offset:1216
    s_waitcnt lgkmcnt(10)
    v_mfma_f32_16x16x32_bf16 v[68:71], v[232:235], v[120:123], v[68:71]
    v_mfma_f32_16x16x32_bf16 v[80:83], v[232:235], v[152:155], v[80:83]
    v_mfma_f32_16x16x32_bf16 v[84:87], v[232:235], v[184:187], v[84:87]
    ds_read_b64_tr_b16 v[232:233], v38 offset:1288
    ds_read_b64_tr_b16 v[234:235], v38 offset:1280
    s_waitcnt lgkmcnt(10)
    v_mfma_f32_16x16x32_bf16 v[68:71], v[236:239], v[124:127], v[68:71]
    v_mfma_f32_16x16x32_bf16 v[80:83], v[236:239], v[156:159], v[80:83]
    v_mfma_f32_16x16x32_bf16 v[84:87], v[236:239], v[188:191], v[84:87]
    ds_read_b64_tr_b16 v[236:237], v38 offset:1352
    ds_read_b64_tr_b16 v[238:239], v38 offset:1344
    s_waitcnt lgkmcnt(10)
    v_mfma_f32_16x16x32_bf16 v[72:75], v[240:243], v[96:99], 0
    v_mfma_f32_16x16x32_bf16 v[84:87], v[240:243], v[128:131], v[84:87]
    v_mfma_f32_16x16x32_bf16 v[88:91], v[240:243], v[160:163], 0
    ds_read_b64_tr_b16 v[240:241], v38 offset:1416
    ds_read_b64_tr_b16 v[242:243], v38 offset:1408
    s_waitcnt lgkmcnt(10)
    v_mfma_f32_16x16x32_bf16 v[72:75], v[244:247], v[100:103], v[72:75]
    v_mfma_f32_16x16x32_bf16 v[84:87], v[244:247], v[132:135], v[84:87]
    v_mfma_f32_16x16x32_bf16 v[88:91], v[244:247], v[164:167], v[88:91]
    ds_read_b64_tr_b16 v[244:245], v38 offset:1480
    ds_read_b64_tr_b16 v[246:247], v38 offset:1472
    s_waitcnt lgkmcnt(10)
    v_mfma_f32_16x16x32_bf16 v[72:75], v[224:227], v[104:107], v[72:75]
    v_mfma_f32_16x16x32_bf16 v[84:87], v[224:227], v[136:139], v[84:87]
    v_mfma_f32_16x16x32_bf16 v[88:91], v[224:227], v[168:171], v[88:91]
    ds_read_b64_tr_b16 v[224:225], v38 offset:1544
    ds_read_b64_tr_b16 v[226:227], v38 offset:1536
    s_waitcnt lgkmcnt(10)
    v_mfma_f32_16x16x32_bf16 v[72:75], v[228:231], v[108:111], v[72:75]
    v_mfma_f32_16x16x32_bf16 v[84:87], v[228:231], v[140:143], v[84:87]
    v_mfma_f32_16x16x32_bf16 v[88:91], v[228:231], v[172:175], v[88:91]
    ds_read_b64_tr_b16 v[228:229], v38 offset:1608
    ds_read_b64_tr_b16 v[230:231], v38 offset:1600
    s_waitcnt lgkmcnt(10)
    v_mfma_f32_16x16x32_bf16 v[72:75], v[232:235], v[112:115], v[72:75]
    v_mfma_f32_16x16x32_bf16 v[84:87], v[232:235], v[144:147], v[84:87]
    v_mfma_f32_16x16x32_bf16 v[88:91], v[232:235], v[176:179], v[88:91]
    ds_read_b64_tr_b16 v[232:233], v38 offset:1672
    ds_read_b64_tr_b16 v[234:235], v38 offset:1664
    s_waitcnt lgkmcnt(10)
    v_mfma_f32_16x16x32_bf16 v[72:75], v[236:239], v[116:119], v[72:75]
    v_mfma_f32_16x16x32_bf16 v[84:87], v[236:239], v[148:151], v[84:87]
    v_mfma_f32_16x16x32_bf16 v[88:91], v[236:239], v[180:183], v[88:91]
    ds_read_b64_tr_b16 v[236:237], v38 offset:1736
    ds_read_b64_tr_b16 v[238:239], v38 offset:1728
    s_waitcnt lgkmcnt(10)
    v_mfma_f32_16x16x32_bf16 v[72:75], v[240:243], v[120:123], v[72:75]
    v_mfma_f32_16x16x32_bf16 v[84:87], v[240:243], v[152:155], v[84:87]
    v_mfma_f32_16x16x32_bf16 v[88:91], v[240:243], v[184:187], v[88:91]
    ds_read_b64_tr_b16 v[240:241], v38 offset:1800
    ds_read_b64_tr_b16 v[242:243], v38 offset:1792
    s_waitcnt lgkmcnt(10)
    v_mfma_f32_16x16x32_bf16 v[72:75], v[244:247], v[124:127], v[72:75]
    v_mfma_f32_16x16x32_bf16 v[84:87], v[244:247], v[156:159], v[84:87]
    v_mfma_f32_16x16x32_bf16 v[88:91], v[244:247], v[188:191], v[88:91]
    ds_read_b64_tr_b16 v[244:245], v38 offset:1864
    ds_read_b64_tr_b16 v[246:247], v38 offset:1856
    s_waitcnt lgkmcnt(10)
    v_mfma_f32_16x16x32_bf16 v[76:79], v[224:227], v[96:99], v[76:79]
    v_mfma_f32_16x16x32_bf16 v[88:91], v[224:227], v[128:131], v[88:91]
    v_mfma_f32_16x16x32_bf16 v[92:95], v[224:227], v[160:163], v[92:95]
    ds_read_b64_tr_b16 v[224:225], v38 offset:1928
    ds_read_b64_tr_b16 v[226:227], v38 offset:1920
    s_waitcnt lgkmcnt(10)
    v_mfma_f32_16x16x32_bf16 v[76:79], v[228:231], v[100:103], v[76:79]
    v_mfma_f32_16x16x32_bf16 v[88:91], v[228:231], v[132:135], v[88:91]
    v_mfma_f32_16x16x32_bf16 v[92:95], v[228:231], v[164:167], v[92:95]
    ds_read_b64_tr_b16 v[228:229], v38 offset:1992
    ds_read_b64_tr_b16 v[230:231], v38 offset:1984
    s_waitcnt lgkmcnt(10)
    v_mfma_f32_16x16x32_bf16 v[76:79], v[232:235], v[104:107], v[76:79]
    v_mfma_f32_16x16x32_bf16 v[88:91], v[232:235], v[136:139], v[88:91]
    v_mfma_f32_16x16x32_bf16 v[92:95], v[232:235], v[168:171], v[92:95]
    ds_read_b64_tr_b16 v[232:233], v38 offset:2056
    ds_read_b64_tr_b16 v[234:235], v38 offset:2048
    s_waitcnt lgkmcnt(10)
    v_mfma_f32_16x16x32_bf16 v[76:79], v[236:239], v[108:111], v[76:79]
    v_mfma_f32_16x16x32_bf16 v[88:91], v[236:239], v[140:143], v[88:91]
    v_mfma_f32_16x16x32_bf16 v[92:95], v[236:239], v[172:175], v[92:95]
    ds_read_b64_tr_b16 v[236:237], v38 offset:2120
    ds_read_b64_tr_b16 v[238:239], v38 offset:2112
    s_waitcnt lgkmcnt(10)
    v_mfma_f32_16x16x32_bf16 v[76:79], v[240:243], v[112:115], v[76:79]
    v_mfma_f32_16x16x32_bf16 v[88:91], v[240:243], v[144:147], v[88:91]
    v_mfma_f32_16x16x32_bf16 v[92:95], v[240:243], v[176:179], v[92:95]
    ds_read_b64_tr_b16 v[240:241], v38 offset:2184
    ds_read_b64_tr_b16 v[242:243], v38 offset:2176
    s_waitcnt lgkmcnt(10)
    v_mfma_f32_16x16x32_bf16 v[76:79], v[244:247], v[116:119], v[76:79]
    v_mfma_f32_16x16x32_bf16 v[88:91], v[244:247], v[148:151], v[88:91]
    v_mfma_f32_16x16x32_bf16 v[92:95], v[244:247], v[180:183], v[92:95]
    ds_read_b64_tr_b16 v[244:245], v38 offset:2248
    ds_read_b64_tr_b16 v[246:247], v38 offset:2240
    s_waitcnt lgkmcnt(10)
    v_mfma_f32_16x16x32_bf16 v[76:79], v[224:227], v[120:123], v[76:79]
    v_mfma_f32_16x16x32_bf16 v[88:91], v[224:227], v[152:155], v[88:91]
    v_mfma_f32_16x16x32_bf16 v[92:95], v[224:227], v[184:187], v[92:95]
    ds_read_b64_tr_b16 v[224:225], v38 offset:2312
    ds_read_b64_tr_b16 v[226:227], v38 offset:2304
    s_waitcnt lgkmcnt(10)
    v_mfma_f32_16x16x32_bf16 v[76:79], v[228:231], v[124:127], v[76:79]
    v_mfma_f32_16x16x32_bf16 v[88:91], v[228:231], v[156:159], v[88:91]
    v_mfma_f32_16x16x32_bf16 v[92:95], v[228:231], v[188:191], v[92:95]
    ds_read_b64_tr_b16 v[228:229], v38 offset:2376
    ds_read_b64_tr_b16 v[230:231], v38 offset:2368
    s_waitcnt lgkmcnt(10)
    v_mfma_f32_16x16x32_bf16 v[80:83], v[232:235], v[96:99], v[80:83]
    v_mfma_f32_16x16x32_bf16 v[92:95], v[232:235], v[128:131], v[92:95]
    ds_read_b64_tr_b16 v[232:233], v38 offset:2440
    ds_read_b64_tr_b16 v[234:235], v38 offset:2432
    s_waitcnt lgkmcnt(10)
    v_mfma_f32_16x16x32_bf16 v[80:83], v[236:239], v[100:103], v[80:83]
    v_mfma_f32_16x16x32_bf16 v[92:95], v[236:239], v[132:135], v[92:95]
    ds_read_b64_tr_b16 v[236:237], v38 offset:2504
    ds_read_b64_tr_b16 v[238:239], v38 offset:2496
    s_waitcnt lgkmcnt(10)
    v_mfma_f32_16x16x32_bf16 v[80:83], v[240:243], v[104:107], v[80:83]
    v_mfma_f32_16x16x32_bf16 v[92:95], v[240:243], v[136:139], v[92:95]
    ds_read_b64_tr_b16 v[240:241], v38 offset:2568
    ds_read_b64_tr_b16 v[242:243], v38 offset:2560
    s_waitcnt lgkmcnt(10)
    v_mfma_f32_16x16x32_bf16 v[80:83], v[244:247], v[108:111], v[80:83]
    v_mfma_f32_16x16x32_bf16 v[92:95], v[244:247], v[140:143], v[92:95]
    ds_read_b64_tr_b16 v[244:245], v38 offset:2632
    ds_read_b64_tr_b16 v[246:247], v38 offset:2624
    s_waitcnt lgkmcnt(10)
    v_mfma_f32_16x16x32_bf16 v[80:83], v[224:227], v[112:115], v[80:83]
    v_mfma_f32_16x16x32_bf16 v[92:95], v[224:227], v[144:147], v[92:95]
    ds_read_b64_tr_b16 v[224:225], v38 offset:2696
    ds_read_b64_tr_b16 v[226:227], v38 offset:2688
    s_waitcnt lgkmcnt(10)
    v_mfma_f32_16x16x32_bf16 v[80:83], v[228:231], v[116:119], v[80:83]
    v_mfma_f32_16x16x32_bf16 v[92:95], v[228:231], v[148:151], v[92:95]
    ds_read_b64_tr_b16 v[228:229], v38 offset:2760
    ds_read_b64_tr_b16 v[230:231], v38 offset:2752
    s_waitcnt lgkmcnt(10)
    v_mfma_f32_16x16x32_bf16 v[80:83], v[232:235], v[120:123], v[80:83]
    v_mfma_f32_16x16x32_bf16 v[92:95], v[232:235], v[152:155], v[92:95]
    ds_read_b64_tr_b16 v[232:233], v38 offset:2824
    ds_read_b64_tr_b16 v[234:235], v38 offset:2816
    s_waitcnt lgkmcnt(10)
    v_mfma_f32_16x16x32_bf16 v[80:83], v[236:239], v[124:127], v[80:83]
    v_mfma_f32_16x16x32_bf16 v[92:95], v[236:239], v[156:159], v[92:95]
    ds_read_b64_tr_b16 v[236:237], v38 offset:2888
    ds_read_b64_tr_b16 v[238:239], v38 offset:2880
    s_waitcnt lgkmcnt(10)
    v_mfma_f32_16x16x32_bf16 v[84:87], v[240:243], v[96:99], v[84:87]
    ds_read_b64_tr_b16 v[240:241], v38 offset:2952
    ds_read_b64_tr_b16 v[242:243], v38 offset:2944
    s_waitcnt lgkmcnt(10)
    v_mfma_f32_16x16x32_bf16 v[84:87], v[244:247], v[100:103], v[84:87]
    ds_read_b64_tr_b16 v[244:245], v38 offset:3016
    ds_read_b64_tr_b16 v[246:247], v38 offset:3008
    s_waitcnt lgkmcnt(10)
    v_mfma_f32_16x16x32_bf16 v[84:87], v[224:227], v[104:107], v[84:87]
    ds_read_b64_tr_b16 v[224:225], v38 offset:3080
    ds_read_b64_tr_b16 v[226:227], v38 offset:3072
    s_waitcnt lgkmcnt(10)
    v_mfma_f32_16x16x32_bf16 v[84:87], v[228:231], v[108:111], v[84:87]
    ds_read_b64_tr_b16 v[228:229], v38 offset:3144
    ds_read_b64_tr_b16 v[230:231], v38 offset:3136
    s_waitcnt lgkmcnt(10)
    v_mfma_f32_16x16x32_bf16 v[84:87], v[232:235], v[112:115], v[84:87]
    ds_read_b64_tr_b16 v[232:233], v38 offset:3208
    ds_read_b64_tr_b16 v[234:235], v38 offset:3200
    s_waitcnt lgkmcnt(10)
    v_mfma_f32_16x16x32_bf16 v[84:87], v[236:239], v[116:119], v[84:87]
    ds_read_b64_tr_b16 v[236:237], v38 offset:3272
    ds_read_b64_tr_b16 v[238:239], v38 offset:3264
    s_waitcnt lgkmcnt(10)
    v_mfma_f32_16x16x32_bf16 v[84:87], v[240:243], v[120:123], v[84:87]
    ds_read_b64_tr_b16 v[240:241], v38 offset:3336
    ds_read_b64_tr_b16 v[242:243], v38 offset:3328
    s_waitcnt lgkmcnt(10)
    v_mfma_f32_16x16x32_bf16 v[84:87], v[244:247], v[124:127], v[84:87]
    ds_read_b64_tr_b16 v[244:245], v38 offset:3400
    ds_read_b64_tr_b16 v[246:247], v38 offset:3392
    s_waitcnt lgkmcnt(10)
    v_mfma_f32_16x16x32_bf16 v[88:91], v[224:227], v[96:99], v[88:91]
    ds_read_b64_tr_b16 v[224:225], v38 offset:3464
    ds_read_b64_tr_b16 v[226:227], v38 offset:3456
    s_waitcnt lgkmcnt(10)
    v_mfma_f32_16x16x32_bf16 v[88:91], v[228:231], v[100:103], v[88:91]
    ds_read_b64_tr_b16 v[228:229], v38 offset:3528
    ds_read_b64_tr_b16 v[230:231], v38 offset:3520
    s_waitcnt lgkmcnt(10)
    v_mfma_f32_16x16x32_bf16 v[88:91], v[232:235], v[104:107], v[88:91]
    ds_read_b64_tr_b16 v[232:233], v38 offset:3592
    ds_read_b64_tr_b16 v[234:235], v38 offset:3584
    s_waitcnt lgkmcnt(10)
    v_mfma_f32_16x16x32_bf16 v[88:91], v[236:239], v[108:111], v[88:91]
    ds_read_b64_tr_b16 v[236:237], v38 offset:3656
    ds_read_b64_tr_b16 v[238:239], v38 offset:3648
    s_waitcnt lgkmcnt(10)
    v_mfma_f32_16x16x32_bf16 v[88:91], v[240:243], v[112:115], v[88:91]
    ds_read_b64_tr_b16 v[240:241], v38 offset:3720
    ds_read_b64_tr_b16 v[242:243], v38 offset:3712
    s_waitcnt lgkmcnt(10)
    v_mfma_f32_16x16x32_bf16 v[88:91], v[244:247], v[116:119], v[88:91]
    ds_read_b64_tr_b16 v[244:245], v38 offset:3784
    ds_read_b64_tr_b16 v[246:247], v38 offset:3776
    s_waitcnt lgkmcnt(10)
    v_mfma_f32_16x16x32_bf16 v[88:91], v[224:227], v[120:123], v[88:91]
    ds_read_b64_tr_b16 v[224:225], v38 offset:3848
    ds_read_b64_tr_b16 v[226:227], v38 offset:3840
    s_waitcnt lgkmcnt(10)
    v_mfma_f32_16x16x32_bf16 v[88:91], v[228:231], v[124:127], v[88:91]
    ds_read_b64_tr_b16 v[228:229], v38 offset:3912
    ds_read_b64_tr_b16 v[230:231], v38 offset:3904
    s_waitcnt lgkmcnt(10)
    v_mfma_f32_16x16x32_bf16 v[92:95], v[232:235], v[96:99], v[92:95]
    ds_read_b64_tr_b16 v[232:233], v38 offset:3976
    ds_read_b64_tr_b16 v[234:235], v38 offset:3968
    s_waitcnt lgkmcnt(10)
    v_mfma_f32_16x16x32_bf16 v[92:95], v[236:239], v[100:103], v[92:95]
    ds_read_b64_tr_b16 v[236:237], v38 offset:4040
    ds_read_b64_tr_b16 v[238:239], v38 offset:4032
    s_waitcnt lgkmcnt(10)
    v_mfma_f32_16x16x32_bf16 v[92:95], v[240:243], v[104:107], v[92:95]
    s_waitcnt lgkmcnt(8)
    v_mfma_f32_16x16x32_bf16 v[92:95], v[244:247], v[108:111], v[92:95]
    s_waitcnt lgkmcnt(6)
    v_mfma_f32_16x16x32_bf16 v[92:95], v[224:227], v[112:115], v[92:95]
    s_waitcnt lgkmcnt(4)
    v_mfma_f32_16x16x32_bf16 v[92:95], v[228:231], v[116:119], v[92:95]
    s_waitcnt lgkmcnt(2)
    v_mfma_f32_16x16x32_bf16 v[92:95], v[232:235], v[120:123], v[92:95]
    s_waitcnt lgkmcnt(0)
    v_mfma_f32_16x16x32_bf16 v[92:95], v[236:239], v[124:127], v[92:95]
    s_branch Lcv_join_2002
Lcv_p1_2001:
    v_mov_b32 v64, 0
    v_mov_b32 v65, 0
    v_mov_b32 v66, 0
    v_mov_b32 v67, 0
    ds_read_b128 v[96:99], v39 offset:960
    ds_read_b128 v[128:131], v39 offset:1472
    ds_read_b128 v[160:163], v39 offset:3008
    ds_read_b128 v[192:195], v39 offset:3520
    ds_read_b64_tr_b16 v[224:225], v38 offset:8
    ds_read_b64_tr_b16 v[226:227], v38 offset:0
    ds_read_b128 v[100:103], v39 offset:896
    ds_read_b128 v[132:135], v39 offset:1408
    ds_read_b128 v[164:167], v39 offset:2944
    ds_read_b128 v[196:199], v39 offset:3456
    ds_read_b64_tr_b16 v[228:229], v38 offset:72
    ds_read_b64_tr_b16 v[230:231], v38 offset:64
    ds_read_b64_tr_b16 v[232:233], v38 offset:136
    ds_read_b64_tr_b16 v[234:235], v38 offset:128
    ds_read_b64_tr_b16 v[236:237], v38 offset:200
    ds_read_b64_tr_b16 v[238:239], v38 offset:192
    ds_read_b64_tr_b16 v[240:241], v38 offset:264
    ds_read_b64_tr_b16 v[242:243], v38 offset:256
    ds_read_b128 v[104:107], v39 offset:832
    ds_read_b128 v[136:139], v39 offset:1344
    ds_read_b128 v[168:171], v39 offset:2880
    ds_read_b128 v[200:203], v39 offset:3392
    ds_read_b64_tr_b16 v[244:245], v38 offset:328
    ds_read_b64_tr_b16 v[246:247], v38 offset:320
    s_waitcnt lgkmcnt(15)
    v_mfma_f32_16x16x32_bf16 v[68:71], v[224:227], v[96:99], 0
    v_mfma_f32_16x16x32_bf16 v[72:75], v[224:227], v[128:131], 0
    v_mfma_f32_16x16x32_bf16 v[84:87], v[224:227], v[160:163], 0
    v_mfma_f32_16x16x32_bf16 v[88:91], v[224:227], v[192:195], 0
    ds_read_b128 v[108:111], v39 offset:768
    ds_read_b128 v[140:143], v39 offset:1280
    ds_read_b128 v[172:175], v39 offset:2816
    ds_read_b128 v[204:207], v39 offset:3328
    ds_read_b64_tr_b16 v[224:225], v38 offset:392
    ds_read_b64_tr_b16 v[226:227], v38 offset:384
    s_waitcnt lgkmcnt(15)
    v_mfma_f32_16x16x32_bf16 v[68:71], v[228:231], v[100:103], v[68:71]
    v_mfma_f32_16x16x32_bf16 v[72:75], v[228:231], v[132:135], v[72:75]
    v_mfma_f32_16x16x32_bf16 v[84:87], v[228:231], v[164:167], v[84:87]
    v_mfma_f32_16x16x32_bf16 v[88:91], v[228:231], v[196:199], v[88:91]
    ds_read_b128 v[112:115], v39 offset:704
    ds_read_b128 v[144:147], v39 offset:1216
    ds_read_b128 v[176:179], v39 offset:2752
    ds_read_b128 v[208:211], v39 offset:3264
    ds_read_b64_tr_b16 v[228:229], v38 offset:456
    ds_read_b64_tr_b16 v[230:231], v38 offset:448
    s_waitcnt lgkmcnt(14)
    v_mfma_f32_16x16x32_bf16 v[68:71], v[232:235], v[104:107], v[68:71]
    v_mfma_f32_16x16x32_bf16 v[72:75], v[232:235], v[136:139], v[72:75]
    v_mfma_f32_16x16x32_bf16 v[84:87], v[232:235], v[168:171], v[84:87]
    v_mfma_f32_16x16x32_bf16 v[88:91], v[232:235], v[200:203], v[88:91]
    ds_read_b128 v[116:119], v39 offset:640
    ds_read_b128 v[148:151], v39 offset:1152
    ds_read_b128 v[180:183], v39 offset:2688
    ds_read_b128 v[212:215], v39 offset:3200
    ds_read_b64_tr_b16 v[232:233], v38 offset:520
    ds_read_b64_tr_b16 v[234:235], v38 offset:512
    s_waitcnt lgkmcnt(14)
    v_mfma_f32_16x16x32_bf16 v[68:71], v[236:239], v[108:111], v[68:71]
    v_mfma_f32_16x16x32_bf16 v[72:75], v[236:239], v[140:143], v[72:75]
    v_mfma_f32_16x16x32_bf16 v[84:87], v[236:239], v[172:175], v[84:87]
    v_mfma_f32_16x16x32_bf16 v[88:91], v[236:239], v[204:207], v[88:91]
    ds_read_b128 v[120:123], v39 offset:576
    ds_read_b128 v[152:155], v39 offset:1088
    ds_read_b128 v[184:187], v39 offset:2624
    ds_read_b128 v[216:219], v39 offset:3136
    ds_read_b64_tr_b16 v[236:237], v38 offset:584
    ds_read_b64_tr_b16 v[238:239], v38 offset:576
    s_waitcnt lgkmcnt(14)
    v_mfma_f32_16x16x32_bf16 v[68:71], v[240:243], v[112:115], v[68:71]
    v_mfma_f32_16x16x32_bf16 v[72:75], v[240:243], v[144:147], v[72:75]
    v_mfma_f32_16x16x32_bf16 v[84:87], v[240:243], v[176:179], v[84:87]
    v_mfma_f32_16x16x32_bf16 v[88:91], v[240:243], v[208:211], v[88:91]
    ds_read_b128 v[124:127], v39 offset:512
    ds_read_b128 v[156:159], v39 offset:1024
    ds_read_b128 v[188:191], v39 offset:2560
    ds_read_b128 v[220:223], v39 offset:3072
    ds_read_b64_tr_b16 v[240:241], v38 offset:648
    ds_read_b64_tr_b16 v[242:243], v38 offset:640
    s_waitcnt lgkmcnt(14)
    v_mfma_f32_16x16x32_bf16 v[68:71], v[244:247], v[116:119], v[68:71]
    v_mfma_f32_16x16x32_bf16 v[72:75], v[244:247], v[148:151], v[72:75]
    v_mfma_f32_16x16x32_bf16 v[84:87], v[244:247], v[180:183], v[84:87]
    v_mfma_f32_16x16x32_bf16 v[88:91], v[244:247], v[212:215], v[88:91]
    ds_read_b64_tr_b16 v[244:245], v38 offset:712
    ds_read_b64_tr_b16 v[246:247], v38 offset:704
    s_waitcnt lgkmcnt(10)
    v_mfma_f32_16x16x32_bf16 v[68:71], v[224:227], v[120:123], v[68:71]
    v_mfma_f32_16x16x32_bf16 v[72:75], v[224:227], v[152:155], v[72:75]
    v_mfma_f32_16x16x32_bf16 v[84:87], v[224:227], v[184:187], v[84:87]
    v_mfma_f32_16x16x32_bf16 v[88:91], v[224:227], v[216:219], v[88:91]
    ds_read_b64_tr_b16 v[224:225], v38 offset:776
    ds_read_b64_tr_b16 v[226:227], v38 offset:768
    s_waitcnt lgkmcnt(6)
    v_mfma_f32_16x16x32_bf16 v[68:71], v[228:231], v[124:127], v[68:71]
    v_mfma_f32_16x16x32_bf16 v[72:75], v[228:231], v[156:159], v[72:75]
    v_mfma_f32_16x16x32_bf16 v[84:87], v[228:231], v[188:191], v[84:87]
    v_mfma_f32_16x16x32_bf16 v[88:91], v[228:231], v[220:223], v[88:91]
    ds_read_b64_tr_b16 v[228:229], v38 offset:840
    ds_read_b64_tr_b16 v[230:231], v38 offset:832
    s_waitcnt lgkmcnt(15)
    v_mfma_f32_16x16x32_bf16 v[72:75], v[232:235], v[96:99], v[72:75]
    v_mfma_f32_16x16x32_bf16 v[76:79], v[232:235], v[128:131], 0
    v_mfma_f32_16x16x32_bf16 v[88:91], v[232:235], v[160:163], v[88:91]
    v_mfma_f32_16x16x32_bf16 v[92:95], v[232:235], v[192:195], 0
    ds_read_b64_tr_b16 v[232:233], v38 offset:904
    ds_read_b64_tr_b16 v[234:235], v38 offset:896
    s_waitcnt lgkmcnt(14)
    v_mfma_f32_16x16x32_bf16 v[72:75], v[236:239], v[100:103], v[72:75]
    v_mfma_f32_16x16x32_bf16 v[76:79], v[236:239], v[132:135], v[76:79]
    v_mfma_f32_16x16x32_bf16 v[88:91], v[236:239], v[164:167], v[88:91]
    v_mfma_f32_16x16x32_bf16 v[92:95], v[236:239], v[196:199], v[92:95]
    ds_read_b64_tr_b16 v[236:237], v38 offset:968
    ds_read_b64_tr_b16 v[238:239], v38 offset:960
    s_waitcnt lgkmcnt(10)
    v_mfma_f32_16x16x32_bf16 v[72:75], v[240:243], v[104:107], v[72:75]
    v_mfma_f32_16x16x32_bf16 v[76:79], v[240:243], v[136:139], v[76:79]
    v_mfma_f32_16x16x32_bf16 v[88:91], v[240:243], v[168:171], v[88:91]
    v_mfma_f32_16x16x32_bf16 v[92:95], v[240:243], v[200:203], v[92:95]
    ds_read_b64_tr_b16 v[240:241], v38 offset:1032
    ds_read_b64_tr_b16 v[242:243], v38 offset:1024
    s_waitcnt lgkmcnt(10)
    v_mfma_f32_16x16x32_bf16 v[72:75], v[244:247], v[108:111], v[72:75]
    v_mfma_f32_16x16x32_bf16 v[76:79], v[244:247], v[140:143], v[76:79]
    v_mfma_f32_16x16x32_bf16 v[88:91], v[244:247], v[172:175], v[88:91]
    v_mfma_f32_16x16x32_bf16 v[92:95], v[244:247], v[204:207], v[92:95]
    ds_read_b64_tr_b16 v[244:245], v38 offset:1096
    ds_read_b64_tr_b16 v[246:247], v38 offset:1088
    s_waitcnt lgkmcnt(10)
    v_mfma_f32_16x16x32_bf16 v[72:75], v[224:227], v[112:115], v[72:75]
    v_mfma_f32_16x16x32_bf16 v[76:79], v[224:227], v[144:147], v[76:79]
    v_mfma_f32_16x16x32_bf16 v[88:91], v[224:227], v[176:179], v[88:91]
    v_mfma_f32_16x16x32_bf16 v[92:95], v[224:227], v[208:211], v[92:95]
    ds_read_b64_tr_b16 v[224:225], v38 offset:1160
    ds_read_b64_tr_b16 v[226:227], v38 offset:1152
    s_waitcnt lgkmcnt(10)
    v_mfma_f32_16x16x32_bf16 v[72:75], v[228:231], v[116:119], v[72:75]
    v_mfma_f32_16x16x32_bf16 v[76:79], v[228:231], v[148:151], v[76:79]
    v_mfma_f32_16x16x32_bf16 v[88:91], v[228:231], v[180:183], v[88:91]
    v_mfma_f32_16x16x32_bf16 v[92:95], v[228:231], v[212:215], v[92:95]
    ds_read_b64_tr_b16 v[228:229], v38 offset:1224
    ds_read_b64_tr_b16 v[230:231], v38 offset:1216
    s_waitcnt lgkmcnt(10)
    v_mfma_f32_16x16x32_bf16 v[72:75], v[232:235], v[120:123], v[72:75]
    v_mfma_f32_16x16x32_bf16 v[76:79], v[232:235], v[152:155], v[76:79]
    v_mfma_f32_16x16x32_bf16 v[88:91], v[232:235], v[184:187], v[88:91]
    v_mfma_f32_16x16x32_bf16 v[92:95], v[232:235], v[216:219], v[92:95]
    ds_read_b64_tr_b16 v[232:233], v38 offset:1288
    ds_read_b64_tr_b16 v[234:235], v38 offset:1280
    s_waitcnt lgkmcnt(10)
    v_mfma_f32_16x16x32_bf16 v[72:75], v[236:239], v[124:127], v[72:75]
    v_mfma_f32_16x16x32_bf16 v[76:79], v[236:239], v[156:159], v[76:79]
    v_mfma_f32_16x16x32_bf16 v[88:91], v[236:239], v[188:191], v[88:91]
    v_mfma_f32_16x16x32_bf16 v[92:95], v[236:239], v[220:223], v[92:95]
    ds_read_b64_tr_b16 v[236:237], v38 offset:1352
    ds_read_b64_tr_b16 v[238:239], v38 offset:1344
    s_waitcnt lgkmcnt(10)
    v_mfma_f32_16x16x32_bf16 v[76:79], v[240:243], v[96:99], v[76:79]
    v_mfma_f32_16x16x32_bf16 v[80:83], v[240:243], v[128:131], 0
    v_mfma_f32_16x16x32_bf16 v[92:95], v[240:243], v[160:163], v[92:95]
    ds_read_b64_tr_b16 v[240:241], v38 offset:1416
    ds_read_b64_tr_b16 v[242:243], v38 offset:1408
    s_waitcnt lgkmcnt(10)
    v_mfma_f32_16x16x32_bf16 v[76:79], v[244:247], v[100:103], v[76:79]
    v_mfma_f32_16x16x32_bf16 v[80:83], v[244:247], v[132:135], v[80:83]
    v_mfma_f32_16x16x32_bf16 v[92:95], v[244:247], v[164:167], v[92:95]
    ds_read_b64_tr_b16 v[244:245], v38 offset:1480
    ds_read_b64_tr_b16 v[246:247], v38 offset:1472
    s_waitcnt lgkmcnt(10)
    v_mfma_f32_16x16x32_bf16 v[76:79], v[224:227], v[104:107], v[76:79]
    v_mfma_f32_16x16x32_bf16 v[80:83], v[224:227], v[136:139], v[80:83]
    v_mfma_f32_16x16x32_bf16 v[92:95], v[224:227], v[168:171], v[92:95]
    ds_read_b64_tr_b16 v[224:225], v38 offset:1544
    ds_read_b64_tr_b16 v[226:227], v38 offset:1536
    s_waitcnt lgkmcnt(10)
    v_mfma_f32_16x16x32_bf16 v[76:79], v[228:231], v[108:111], v[76:79]
    v_mfma_f32_16x16x32_bf16 v[80:83], v[228:231], v[140:143], v[80:83]
    v_mfma_f32_16x16x32_bf16 v[92:95], v[228:231], v[172:175], v[92:95]
    ds_read_b64_tr_b16 v[228:229], v38 offset:1608
    ds_read_b64_tr_b16 v[230:231], v38 offset:1600
    s_waitcnt lgkmcnt(10)
    v_mfma_f32_16x16x32_bf16 v[76:79], v[232:235], v[112:115], v[76:79]
    v_mfma_f32_16x16x32_bf16 v[80:83], v[232:235], v[144:147], v[80:83]
    v_mfma_f32_16x16x32_bf16 v[92:95], v[232:235], v[176:179], v[92:95]
    ds_read_b64_tr_b16 v[232:233], v38 offset:1672
    ds_read_b64_tr_b16 v[234:235], v38 offset:1664
    s_waitcnt lgkmcnt(10)
    v_mfma_f32_16x16x32_bf16 v[76:79], v[236:239], v[116:119], v[76:79]
    v_mfma_f32_16x16x32_bf16 v[80:83], v[236:239], v[148:151], v[80:83]
    v_mfma_f32_16x16x32_bf16 v[92:95], v[236:239], v[180:183], v[92:95]
    ds_read_b64_tr_b16 v[236:237], v38 offset:1736
    ds_read_b64_tr_b16 v[238:239], v38 offset:1728
    s_waitcnt lgkmcnt(10)
    v_mfma_f32_16x16x32_bf16 v[76:79], v[240:243], v[120:123], v[76:79]
    v_mfma_f32_16x16x32_bf16 v[80:83], v[240:243], v[152:155], v[80:83]
    v_mfma_f32_16x16x32_bf16 v[92:95], v[240:243], v[184:187], v[92:95]
    ds_read_b64_tr_b16 v[240:241], v38 offset:1800
    ds_read_b64_tr_b16 v[242:243], v38 offset:1792
    s_waitcnt lgkmcnt(10)
    v_mfma_f32_16x16x32_bf16 v[76:79], v[244:247], v[124:127], v[76:79]
    v_mfma_f32_16x16x32_bf16 v[80:83], v[244:247], v[156:159], v[80:83]
    v_mfma_f32_16x16x32_bf16 v[92:95], v[244:247], v[188:191], v[92:95]
    ds_read_b64_tr_b16 v[244:245], v38 offset:1864
    ds_read_b64_tr_b16 v[246:247], v38 offset:1856
    s_waitcnt lgkmcnt(10)
    v_mfma_f32_16x16x32_bf16 v[80:83], v[224:227], v[96:99], v[80:83]
    v_mfma_f32_16x16x32_bf16 v[84:87], v[224:227], v[128:131], v[84:87]
    ds_read_b64_tr_b16 v[224:225], v38 offset:1928
    ds_read_b64_tr_b16 v[226:227], v38 offset:1920
    s_waitcnt lgkmcnt(10)
    v_mfma_f32_16x16x32_bf16 v[80:83], v[228:231], v[100:103], v[80:83]
    v_mfma_f32_16x16x32_bf16 v[84:87], v[228:231], v[132:135], v[84:87]
    ds_read_b64_tr_b16 v[228:229], v38 offset:1992
    ds_read_b64_tr_b16 v[230:231], v38 offset:1984
    s_waitcnt lgkmcnt(10)
    v_mfma_f32_16x16x32_bf16 v[80:83], v[232:235], v[104:107], v[80:83]
    v_mfma_f32_16x16x32_bf16 v[84:87], v[232:235], v[136:139], v[84:87]
    ds_read_b64_tr_b16 v[232:233], v38 offset:2056
    ds_read_b64_tr_b16 v[234:235], v38 offset:2048
    s_waitcnt lgkmcnt(10)
    v_mfma_f32_16x16x32_bf16 v[80:83], v[236:239], v[108:111], v[80:83]
    v_mfma_f32_16x16x32_bf16 v[84:87], v[236:239], v[140:143], v[84:87]
    ds_read_b64_tr_b16 v[236:237], v38 offset:2120
    ds_read_b64_tr_b16 v[238:239], v38 offset:2112
    s_waitcnt lgkmcnt(10)
    v_mfma_f32_16x16x32_bf16 v[80:83], v[240:243], v[112:115], v[80:83]
    v_mfma_f32_16x16x32_bf16 v[84:87], v[240:243], v[144:147], v[84:87]
    ds_read_b64_tr_b16 v[240:241], v38 offset:2184
    ds_read_b64_tr_b16 v[242:243], v38 offset:2176
    s_waitcnt lgkmcnt(10)
    v_mfma_f32_16x16x32_bf16 v[80:83], v[244:247], v[116:119], v[80:83]
    v_mfma_f32_16x16x32_bf16 v[84:87], v[244:247], v[148:151], v[84:87]
    ds_read_b64_tr_b16 v[244:245], v38 offset:2248
    ds_read_b64_tr_b16 v[246:247], v38 offset:2240
    s_waitcnt lgkmcnt(10)
    v_mfma_f32_16x16x32_bf16 v[80:83], v[224:227], v[120:123], v[80:83]
    v_mfma_f32_16x16x32_bf16 v[84:87], v[224:227], v[152:155], v[84:87]
    ds_read_b64_tr_b16 v[224:225], v38 offset:2312
    ds_read_b64_tr_b16 v[226:227], v38 offset:2304
    s_waitcnt lgkmcnt(10)
    v_mfma_f32_16x16x32_bf16 v[80:83], v[228:231], v[124:127], v[80:83]
    v_mfma_f32_16x16x32_bf16 v[84:87], v[228:231], v[156:159], v[84:87]
    ds_read_b64_tr_b16 v[228:229], v38 offset:2376
    ds_read_b64_tr_b16 v[230:231], v38 offset:2368
    s_waitcnt lgkmcnt(10)
    v_mfma_f32_16x16x32_bf16 v[84:87], v[232:235], v[96:99], v[84:87]
    v_mfma_f32_16x16x32_bf16 v[88:91], v[232:235], v[128:131], v[88:91]
    ds_read_b64_tr_b16 v[232:233], v38 offset:2440
    ds_read_b64_tr_b16 v[234:235], v38 offset:2432
    s_waitcnt lgkmcnt(10)
    v_mfma_f32_16x16x32_bf16 v[84:87], v[236:239], v[100:103], v[84:87]
    v_mfma_f32_16x16x32_bf16 v[88:91], v[236:239], v[132:135], v[88:91]
    ds_read_b64_tr_b16 v[236:237], v38 offset:2504
    ds_read_b64_tr_b16 v[238:239], v38 offset:2496
    s_waitcnt lgkmcnt(10)
    v_mfma_f32_16x16x32_bf16 v[84:87], v[240:243], v[104:107], v[84:87]
    v_mfma_f32_16x16x32_bf16 v[88:91], v[240:243], v[136:139], v[88:91]
    ds_read_b64_tr_b16 v[240:241], v38 offset:2568
    ds_read_b64_tr_b16 v[242:243], v38 offset:2560
    s_waitcnt lgkmcnt(10)
    v_mfma_f32_16x16x32_bf16 v[84:87], v[244:247], v[108:111], v[84:87]
    v_mfma_f32_16x16x32_bf16 v[88:91], v[244:247], v[140:143], v[88:91]
    ds_read_b64_tr_b16 v[244:245], v38 offset:2632
    ds_read_b64_tr_b16 v[246:247], v38 offset:2624
    s_waitcnt lgkmcnt(10)
    v_mfma_f32_16x16x32_bf16 v[84:87], v[224:227], v[112:115], v[84:87]
    v_mfma_f32_16x16x32_bf16 v[88:91], v[224:227], v[144:147], v[88:91]
    ds_read_b64_tr_b16 v[224:225], v38 offset:2696
    ds_read_b64_tr_b16 v[226:227], v38 offset:2688
    s_waitcnt lgkmcnt(10)
    v_mfma_f32_16x16x32_bf16 v[84:87], v[228:231], v[116:119], v[84:87]
    v_mfma_f32_16x16x32_bf16 v[88:91], v[228:231], v[148:151], v[88:91]
    ds_read_b64_tr_b16 v[228:229], v38 offset:2760
    ds_read_b64_tr_b16 v[230:231], v38 offset:2752
    s_waitcnt lgkmcnt(10)
    v_mfma_f32_16x16x32_bf16 v[84:87], v[232:235], v[120:123], v[84:87]
    v_mfma_f32_16x16x32_bf16 v[88:91], v[232:235], v[152:155], v[88:91]
    ds_read_b64_tr_b16 v[232:233], v38 offset:2824
    ds_read_b64_tr_b16 v[234:235], v38 offset:2816
    s_waitcnt lgkmcnt(10)
    v_mfma_f32_16x16x32_bf16 v[84:87], v[236:239], v[124:127], v[84:87]
    v_mfma_f32_16x16x32_bf16 v[88:91], v[236:239], v[156:159], v[88:91]
    ds_read_b64_tr_b16 v[236:237], v38 offset:2888
    ds_read_b64_tr_b16 v[238:239], v38 offset:2880
    s_waitcnt lgkmcnt(10)
    v_mfma_f32_16x16x32_bf16 v[88:91], v[240:243], v[96:99], v[88:91]
    v_mfma_f32_16x16x32_bf16 v[92:95], v[240:243], v[128:131], v[92:95]
    ds_read_b64_tr_b16 v[240:241], v38 offset:2952
    ds_read_b64_tr_b16 v[242:243], v38 offset:2944
    s_waitcnt lgkmcnt(10)
    v_mfma_f32_16x16x32_bf16 v[88:91], v[244:247], v[100:103], v[88:91]
    v_mfma_f32_16x16x32_bf16 v[92:95], v[244:247], v[132:135], v[92:95]
    ds_read_b64_tr_b16 v[244:245], v38 offset:3016
    ds_read_b64_tr_b16 v[246:247], v38 offset:3008
    s_waitcnt lgkmcnt(10)
    v_mfma_f32_16x16x32_bf16 v[88:91], v[224:227], v[104:107], v[88:91]
    v_mfma_f32_16x16x32_bf16 v[92:95], v[224:227], v[136:139], v[92:95]
    ds_read_b64_tr_b16 v[224:225], v38 offset:3080
    ds_read_b64_tr_b16 v[226:227], v38 offset:3072
    s_waitcnt lgkmcnt(10)
    v_mfma_f32_16x16x32_bf16 v[88:91], v[228:231], v[108:111], v[88:91]
    v_mfma_f32_16x16x32_bf16 v[92:95], v[228:231], v[140:143], v[92:95]
    ds_read_b64_tr_b16 v[228:229], v38 offset:3144
    ds_read_b64_tr_b16 v[230:231], v38 offset:3136
    s_waitcnt lgkmcnt(10)
    v_mfma_f32_16x16x32_bf16 v[88:91], v[232:235], v[112:115], v[88:91]
    v_mfma_f32_16x16x32_bf16 v[92:95], v[232:235], v[144:147], v[92:95]
    ds_read_b64_tr_b16 v[232:233], v38 offset:3208
    ds_read_b64_tr_b16 v[234:235], v38 offset:3200
    s_waitcnt lgkmcnt(10)
    v_mfma_f32_16x16x32_bf16 v[88:91], v[236:239], v[116:119], v[88:91]
    v_mfma_f32_16x16x32_bf16 v[92:95], v[236:239], v[148:151], v[92:95]
    ds_read_b64_tr_b16 v[236:237], v38 offset:3272
    ds_read_b64_tr_b16 v[238:239], v38 offset:3264
    s_waitcnt lgkmcnt(10)
    v_mfma_f32_16x16x32_bf16 v[88:91], v[240:243], v[120:123], v[88:91]
    v_mfma_f32_16x16x32_bf16 v[92:95], v[240:243], v[152:155], v[92:95]
    ds_read_b64_tr_b16 v[240:241], v38 offset:3336
    ds_read_b64_tr_b16 v[242:243], v38 offset:3328
    s_waitcnt lgkmcnt(10)
    v_mfma_f32_16x16x32_bf16 v[88:91], v[244:247], v[124:127], v[88:91]
    v_mfma_f32_16x16x32_bf16 v[92:95], v[244:247], v[156:159], v[92:95]
    ds_read_b64_tr_b16 v[244:245], v38 offset:3400
    ds_read_b64_tr_b16 v[246:247], v38 offset:3392
    s_waitcnt lgkmcnt(10)
    v_mfma_f32_16x16x32_bf16 v[92:95], v[224:227], v[96:99], v[92:95]
    ds_read_b64_tr_b16 v[224:225], v38 offset:3464
    ds_read_b64_tr_b16 v[226:227], v38 offset:3456
    s_waitcnt lgkmcnt(10)
    v_mfma_f32_16x16x32_bf16 v[92:95], v[228:231], v[100:103], v[92:95]
    ds_read_b64_tr_b16 v[228:229], v38 offset:3528
    ds_read_b64_tr_b16 v[230:231], v38 offset:3520
    s_waitcnt lgkmcnt(10)
    v_mfma_f32_16x16x32_bf16 v[92:95], v[232:235], v[104:107], v[92:95]
    s_waitcnt lgkmcnt(8)
    v_mfma_f32_16x16x32_bf16 v[92:95], v[236:239], v[108:111], v[92:95]
    s_waitcnt lgkmcnt(6)
    v_mfma_f32_16x16x32_bf16 v[92:95], v[240:243], v[112:115], v[92:95]
    s_waitcnt lgkmcnt(4)
    v_mfma_f32_16x16x32_bf16 v[92:95], v[244:247], v[116:119], v[92:95]
    s_waitcnt lgkmcnt(2)
    v_mfma_f32_16x16x32_bf16 v[92:95], v[224:227], v[120:123], v[92:95]
    s_waitcnt lgkmcnt(0)
    v_mfma_f32_16x16x32_bf16 v[92:95], v[228:231], v[124:127], v[92:95]
Lcv_join_2002:
    s_setprio 0
    s_barrier
    s_lshl_b32 s11, s6, 12
    s_add_u32 s11, s11, s10
    v_lshlrev_b32 v6, 4, v1
    v_add_u32 v7, s11, v6
    s_xor_b32 s26, s6, 1
    s_lshl_b32 s26, s26, 12
    s_add_u32 s26, s26, s10
    v_add_u32 v6, s26, v6

    s_cmp_eq_u32 s6, 1
    s_cbranch_scc1 Lcv_e1_2003
    ds_write_b128 v7, v[80:83] offset:0
    ds_write_b128 v7, v[84:87] offset:1024
    ds_write_b128 v7, v[88:91] offset:2048
    ds_write_b128 v7, v[92:95] offset:3072
    s_waitcnt lgkmcnt(0)
    s_barrier
    ds_read_b128 v[8:11], v6 offset:0
    ds_read_b128 v[12:15], v6 offset:1024
    ds_read_b128 v[16:19], v6 offset:2048
    ds_read_b128 v[20:23], v6 offset:3072
    s_waitcnt lgkmcnt(3)
    v_add_f32 v8, v8, v64
    v_add_f32 v9, v9, v65
    v_add_f32 v10, v10, v66
    v_add_f32 v11, v11, v67
    v_cvt_pk_bf16_f32 v24, v8, v9
    v_cvt_pk_bf16_f32 v25, v10, v11
    s_waitcnt lgkmcnt(2)
    v_add_f32 v12, v12, v68
    v_add_f32 v13, v13, v69
    v_add_f32 v14, v14, v70
    v_add_f32 v15, v15, v71
    v_cvt_pk_bf16_f32 v26, v12, v13
    v_cvt_pk_bf16_f32 v27, v14, v15
    s_nop 1
    v_permlane16_swap_b32 v24, v26
    v_permlane16_swap_b32 v25, v27
    buffer_store_dwordx4 v[24:27], v60, s[20:23], 0 offen offset:0 sc1
    s_waitcnt lgkmcnt(1)
    v_add_f32 v16, v16, v72
    v_add_f32 v17, v17, v73
    v_add_f32 v18, v18, v74
    v_add_f32 v19, v19, v75
    v_cvt_pk_bf16_f32 v28, v16, v17
    v_cvt_pk_bf16_f32 v29, v18, v19
    s_waitcnt lgkmcnt(0)
    v_add_f32 v20, v20, v76
    v_add_f32 v21, v21, v77
    v_add_f32 v22, v22, v78
    v_add_f32 v23, v23, v79
    v_cvt_pk_bf16_f32 v30, v20, v21
    v_cvt_pk_bf16_f32 v31, v22, v23
    s_nop 1
    v_permlane16_swap_b32 v28, v30
    v_permlane16_swap_b32 v29, v31
    buffer_store_dwordx4 v[28:31], v60, s[20:23], 0 offen offset:1024 sc1
    s_branch Lcv_e2_2004
Lcv_e1_2003:
    ds_write_b128 v7, v[64:67] offset:0
    ds_write_b128 v7, v[68:71] offset:1024
    ds_write_b128 v7, v[72:75] offset:2048
    ds_write_b128 v7, v[76:79] offset:3072
    s_waitcnt lgkmcnt(0)
    s_barrier
    ds_read_b128 v[8:11], v6 offset:0
    ds_read_b128 v[12:15], v6 offset:1024
    ds_read_b128 v[16:19], v6 offset:2048
    ds_read_b128 v[20:23], v6 offset:3072
    s_waitcnt lgkmcnt(3)
    v_add_f32 v8, v8, v80
    v_add_f32 v9, v9, v81
    v_add_f32 v10, v10, v82
    v_add_f32 v11, v11, v83
    v_cvt_pk_bf16_f32 v24, v8, v9
    v_cvt_pk_bf16_f32 v25, v10, v11
    s_waitcnt lgkmcnt(2)
    v_add_f32 v12, v12, v84
    v_add_f32 v13, v13, v85
    v_add_f32 v14, v14, v86
    v_add_f32 v15, v15, v87
    v_cvt_pk_bf16_f32 v26, v12, v13
    v_cvt_pk_bf16_f32 v27, v14, v15
    s_nop 1
    v_permlane16_swap_b32 v24, v26
    v_permlane16_swap_b32 v25, v27
    buffer_store_dwordx4 v[24:27], v60, s[20:23], 0 offen offset:2048 sc1
    s_waitcnt lgkmcnt(1)
    v_add_f32 v16, v16, v88
    v_add_f32 v17, v17, v89
    v_add_f32 v18, v18, v90
    v_add_f32 v19, v19, v91
    v_cvt_pk_bf16_f32 v28, v16, v17
    v_cvt_pk_bf16_f32 v29, v18, v19
    s_waitcnt lgkmcnt(0)
    v_add_f32 v20, v20, v92
    v_add_f32 v21, v21, v93
    v_add_f32 v22, v22, v94
    v_add_f32 v23, v23, v95
    v_cvt_pk_bf16_f32 v30, v20, v21
    v_cvt_pk_bf16_f32 v31, v22, v23
    s_nop 1
    v_permlane16_swap_b32 v28, v30
    v_permlane16_swap_b32 v29, v31
    buffer_store_dwordx4 v[28:31], v60, s[20:23], 0 offen offset:3072 sc1
Lcv_e2_2004:
    s_waitcnt vmcnt(0)
    s_barrier
    v_cmp_eq_u32 vcc, 0, v0
    s_and_saveexec_b64 s[24:25], vcc
    s_cbranch_execz Lcv_f_2005
    s_lshr_b32 s26, s48, 5
    s_lshl_b32 s26, s26, 7
    s_and_b32 s27, s48, 31
    s_lshl_b32 s27, s27, 2
    s_add_u32 s26, s26, s27
    s_add_u32 s26, s26, 17893376
    v_mov_b32 v6, s26
    v_mov_b32 v7, 1
    global_store_dword v6, v7, s[4:5] sc1
Lcv_f_2005:
    s_mov_b64 exec, s[24:25]

    s_endpgm
L1_g2:
    s_sub_u32 s48, s2, 224
    s_setprio 3
    s_load_dwordx2 s[4:5], s[0:1], 104
    s_load_dwordx2 s[6:7], s[0:1], 0
    s_load_dwordx2 s[44:45], s[0:1], 88
    v_and_b32 v1, 63, v0
    v_lshrrev_b32 v2, 6, v0
    s_nop 0
    v_readfirstlane_b32 s8, v2
    s_and_b32 s9, s48, 31
    s_lshr_b32 s10, s48, 5
    v_lshlrev_b32 v3, 4, v1
    s_waitcnt lgkmcnt(0)

    s_add_u32 s12, s4, 8945664
    s_addc_u32 s13, s5, 0
    s_mov_b32 s14, 1605632
    s_mov_b32 s15, 0x00020000
    s_add_u32 s16, s4, 10551296
    s_addc_u32 s17, s5, 0
    s_mov_b32 s18, 7340032
    s_mov_b32 s19, 0x00020000
    s_add_u32 s20, s4, 3670016
    s_addc_u32 s21, s5, 0
    s_mov_b32 s22, 1835008
    s_mov_b32 s23, 0x00020000
    s_mov_b32 s24, s6
    s_mov_b32 s25, s7
    s_mov_b32 s26, 1835008
    s_mov_b32 s27, 0x00020000
    s_mov_b32 s28, s44
    s_mov_b32 s29, s45
    s_mov_b32 s30, 1835008
    s_mov_b32 s31, 0x00020000
    s_mul_i32 s32, s8, 28
    s_mul_i32 s33, s10, 224
    s_add_u32 s33, s33, s32
    s_lshl_b32 s33, s33, 10
    s_add_u32 s34, s33, 114688
    s_mul_i32 s35, s9, 224
    s_add_u32 s35, s35, s32
    s_lshl_b32 s35, s35, 10
    s_add_u32 s36, s35, 114688

    buffer_load_dwordx4 v[72:75], v3, s[12:15], s33 offen offset:0
    buffer_load_dwordx4 v[80:83], v3, s[16:19], s35 offen offset:0
    buffer_load_dwordx4 v[76:79], v3, s[12:15], s34 offen offset:0
    buffer_load_dwordx4 v[84:87], v3, s[16:19], s36 offen offset:0
    buffer_load_dwordx4 v[88:91], v3, s[12:15], s33 offen offset:1024
    buffer_load_dwordx4 v[96:99], v3, s[16:19], s35 offen offset:1024
    buffer_load_dwordx4 v[92:95], v3, s[12:15], s34 offen offset:1024
    buffer_load_dwordx4 v[100:103], v3, s[16:19], s36 offen offset:1024
    buffer_load_dwordx4 v[104:107], v3, s[12:15], s33 offen offset:2048
    buffer_load_dwordx4 v[112:115], v3, s[16:19], s35 offen offset:2048
    buffer_load_dwordx4 v[108:111], v3, s[12:15], s34 offen offset:2048
    buffer_load_dwordx4 v[116:119], v3, s[16:19], s36 offen offset:2048
    s_waitcnt vmcnt(8)
    v_mfma_f32_32x32x16_bf16 v[8:23], v[72:75], v[80:83], 0
    buffer_load_dwordx4 v[120:123], v3, s[12:15], s33 offen offset:3072
    v_mfma_f32_32x32x16_bf16 v[24:39], v[72:75], v[84:87], 0
    buffer_load_dwordx4 v[128:131], v3, s[16:19], s35 offen offset:3072
    v_mfma_f32_32x32x16_bf16 v[40:55], v[76:79], v[80:83], 0
    buffer_load_dwordx4 v[124:127], v3, s[12:15], s34 offen offset:3072
    v_mfma_f32_32x32x16_bf16 v[56:71], v[76:79], v[84:87], 0
    buffer_load_dwordx4 v[132:135], v3, s[16:19], s36 offen offset:3072
    s_add_u32 s33, s33, 4096
    s_add_u32 s34, s34, 4096
    s_add_u32 s35, s35, 4096
    s_add_u32 s36, s36, 4096
    s_waitcnt vmcnt(8)
    v_mfma_f32_32x32x16_bf16 v[8:23], v[88:91], v[96:99], v[8:23]
    buffer_load_dwordx4 v[72:75], v3, s[12:15], s33 offen offset:0
    v_mfma_f32_32x32x16_bf16 v[24:39], v[88:91], v[100:103], v[24:39]
    buffer_load_dwordx4 v[80:83], v3, s[16:19], s35 offen offset:0
    v_mfma_f32_32x32x16_bf16 v[40:55], v[92:95], v[96:99], v[40:55]
    buffer_load_dwordx4 v[76:79], v3, s[12:15], s34 offen offset:0
    v_mfma_f32_32x32x16_bf16 v[56:71], v[92:95], v[100:103], v[56:71]
    buffer_load_dwordx4 v[84:87], v3, s[16:19], s36 offen offset:0
    s_waitcnt vmcnt(8)
    v_mfma_f32_32x32x16_bf16 v[8:23], v[104:107], v[112:115], v[8:23]
    buffer_load_dwordx4 v[88:91], v3, s[12:15], s33 offen offset:1024
    v_mfma_f32_32x32x16_bf16 v[24:39], v[104:107], v[116:119], v[24:39]
    buffer_load_dwordx4 v[96:99], v3, s[16:19], s35 offen offset:1024
    v_mfma_f32_32x32x16_bf16 v[40:55], v[108:111], v[112:115], v[40:55]
    buffer_load_dwordx4 v[92:95], v3, s[12:15], s34 offen offset:1024
    v_mfma_f32_32x32x16_bf16 v[56:71], v[108:111], v[116:119], v[56:71]
    buffer_load_dwordx4 v[100:103], v3, s[16:19], s36 offen offset:1024
    s_waitcnt vmcnt(8)
    v_mfma_f32_32x32x16_bf16 v[8:23], v[120:123], v[128:131], v[8:23]
    buffer_load_dwordx4 v[104:107], v3, s[12:15], s33 offen offset:2048
    v_mfma_f32_32x32x16_bf16 v[24:39], v[120:123], v[132:135], v[24:39]
    buffer_load_dwordx4 v[112:115], v3, s[16:19], s35 offen offset:2048
    v_mfma_f32_32x32x16_bf16 v[40:55], v[124:127], v[128:131], v[40:55]
    buffer_load_dwordx4 v[108:111], v3, s[12:15], s34 offen offset:2048
    v_mfma_f32_32x32x16_bf16 v[56:71], v[124:127], v[132:135], v[56:71]
    buffer_load_dwordx4 v[116:119], v3, s[16:19], s36 offen offset:2048
    s_waitcnt vmcnt(8)
    v_mfma_f32_32x32x16_bf16 v[8:23], v[72:75], v[80:83], v[8:23]
    buffer_load_dwordx4 v[120:123], v3, s[12:15], s33 offen offset:3072
    v_mfma_f32_32x32x16_bf16 v[24:39], v[72:75], v[84:87], v[24:39]
    buffer_load_dwordx4 v[128:131], v3, s[16:19], s35 offen offset:3072
    v_mfma_f32_32x32x16_bf16 v[40:55], v[76:79], v[80:83], v[40:55]
    buffer_load_dwordx4 v[124:127], v3, s[12:15], s34 offen offset:3072
    v_mfma_f32_32x32x16_bf16 v[56:71], v[76:79], v[84:87], v[56:71]
    buffer_load_dwordx4 v[132:135], v3, s[16:19], s36 offen offset:3072
    s_add_u32 s33, s33, 4096
    s_add_u32 s34, s34, 4096
    s_add_u32 s35, s35, 4096
    s_add_u32 s36, s36, 4096
    s_waitcnt vmcnt(8)
    v_mfma_f32_32x32x16_bf16 v[8:23], v[88:91], v[96:99], v[8:23]
    buffer_load_dwordx4 v[72:75], v3, s[12:15], s33 offen offset:0
    v_mfma_f32_32x32x16_bf16 v[24:39], v[88:91], v[100:103], v[24:39]
    buffer_load_dwordx4 v[80:83], v3, s[16:19], s35 offen offset:0
    v_mfma_f32_32x32x16_bf16 v[40:55], v[92:95], v[96:99], v[40:55]
    buffer_load_dwordx4 v[76:79], v3, s[12:15], s34 offen offset:0
    v_mfma_f32_32x32x16_bf16 v[56:71], v[92:95], v[100:103], v[56:71]
    buffer_load_dwordx4 v[84:87], v3, s[16:19], s36 offen offset:0
    s_waitcnt vmcnt(8)
    v_mfma_f32_32x32x16_bf16 v[8:23], v[104:107], v[112:115], v[8:23]
    buffer_load_dwordx4 v[88:91], v3, s[12:15], s33 offen offset:1024
    v_mfma_f32_32x32x16_bf16 v[24:39], v[104:107], v[116:119], v[24:39]
    buffer_load_dwordx4 v[96:99], v3, s[16:19], s35 offen offset:1024
    v_mfma_f32_32x32x16_bf16 v[40:55], v[108:111], v[112:115], v[40:55]
    buffer_load_dwordx4 v[92:95], v3, s[12:15], s34 offen offset:1024
    v_mfma_f32_32x32x16_bf16 v[56:71], v[108:111], v[116:119], v[56:71]
    buffer_load_dwordx4 v[100:103], v3, s[16:19], s36 offen offset:1024
    s_waitcnt vmcnt(8)
    v_mfma_f32_32x32x16_bf16 v[8:23], v[120:123], v[128:131], v[8:23]
    buffer_load_dwordx4 v[104:107], v3, s[12:15], s33 offen offset:2048
    v_mfma_f32_32x32x16_bf16 v[24:39], v[120:123], v[132:135], v[24:39]
    buffer_load_dwordx4 v[112:115], v3, s[16:19], s35 offen offset:2048
    v_mfma_f32_32x32x16_bf16 v[40:55], v[124:127], v[128:131], v[40:55]
    buffer_load_dwordx4 v[108:111], v3, s[12:15], s34 offen offset:2048
    v_mfma_f32_32x32x16_bf16 v[56:71], v[124:127], v[132:135], v[56:71]
    buffer_load_dwordx4 v[116:119], v3, s[16:19], s36 offen offset:2048
    s_waitcnt vmcnt(8)
    v_mfma_f32_32x32x16_bf16 v[8:23], v[72:75], v[80:83], v[8:23]
    buffer_load_dwordx4 v[120:123], v3, s[12:15], s33 offen offset:3072
    v_mfma_f32_32x32x16_bf16 v[24:39], v[72:75], v[84:87], v[24:39]
    buffer_load_dwordx4 v[128:131], v3, s[16:19], s35 offen offset:3072
    v_mfma_f32_32x32x16_bf16 v[40:55], v[76:79], v[80:83], v[40:55]
    buffer_load_dwordx4 v[124:127], v3, s[12:15], s34 offen offset:3072
    v_mfma_f32_32x32x16_bf16 v[56:71], v[76:79], v[84:87], v[56:71]
    buffer_load_dwordx4 v[132:135], v3, s[16:19], s36 offen offset:3072
    s_add_u32 s33, s33, 4096
    s_add_u32 s34, s34, 4096
    s_add_u32 s35, s35, 4096
    s_add_u32 s36, s36, 4096
    s_waitcnt vmcnt(8)
    v_mfma_f32_32x32x16_bf16 v[8:23], v[88:91], v[96:99], v[8:23]
    buffer_load_dwordx4 v[72:75], v3, s[12:15], s33 offen offset:0
    v_mfma_f32_32x32x16_bf16 v[24:39], v[88:91], v[100:103], v[24:39]
    buffer_load_dwordx4 v[80:83], v3, s[16:19], s35 offen offset:0
    v_mfma_f32_32x32x16_bf16 v[40:55], v[92:95], v[96:99], v[40:55]
    buffer_load_dwordx4 v[76:79], v3, s[12:15], s34 offen offset:0
    v_mfma_f32_32x32x16_bf16 v[56:71], v[92:95], v[100:103], v[56:71]
    buffer_load_dwordx4 v[84:87], v3, s[16:19], s36 offen offset:0
    s_waitcnt vmcnt(8)
    v_mfma_f32_32x32x16_bf16 v[8:23], v[104:107], v[112:115], v[8:23]
    buffer_load_dwordx4 v[88:91], v3, s[12:15], s33 offen offset:1024
    v_mfma_f32_32x32x16_bf16 v[24:39], v[104:107], v[116:119], v[24:39]
    buffer_load_dwordx4 v[96:99], v3, s[16:19], s35 offen offset:1024
    v_mfma_f32_32x32x16_bf16 v[40:55], v[108:111], v[112:115], v[40:55]
    buffer_load_dwordx4 v[92:95], v3, s[12:15], s34 offen offset:1024
    v_mfma_f32_32x32x16_bf16 v[56:71], v[108:111], v[116:119], v[56:71]
    buffer_load_dwordx4 v[100:103], v3, s[16:19], s36 offen offset:1024
    s_waitcnt vmcnt(8)
    v_mfma_f32_32x32x16_bf16 v[8:23], v[120:123], v[128:131], v[8:23]
    buffer_load_dwordx4 v[104:107], v3, s[12:15], s33 offen offset:2048
    v_mfma_f32_32x32x16_bf16 v[24:39], v[120:123], v[132:135], v[24:39]
    buffer_load_dwordx4 v[112:115], v3, s[16:19], s35 offen offset:2048
    v_mfma_f32_32x32x16_bf16 v[40:55], v[124:127], v[128:131], v[40:55]
    buffer_load_dwordx4 v[108:111], v3, s[12:15], s34 offen offset:2048
    v_mfma_f32_32x32x16_bf16 v[56:71], v[124:127], v[132:135], v[56:71]
    buffer_load_dwordx4 v[116:119], v3, s[16:19], s36 offen offset:2048
    s_lshr_b32 s37, s8, 1
    s_and_b32 s38, s8, 1
    s_lshl_b32 s39, s9, 6
    s_lshl_b32 s40, s38, 5
    s_add_u32 s39, s39, s40
    s_lshl_b32 s41, s10, 6
    s_lshl_b32 s40, s37, 5
    s_add_u32 s41, s41, s40
    s_mul_i32 s42, s39, 896
    s_lshl_b32 s40, s41, 1
    s_add_u32 s42, s42, s40
    v_and_b32 v4, 31, v1
    v_lshrrev_b32 v5, 5, v1
    v_mul_u32_u24 v6, 896, v4
    v_lshl_add_u32 v155, v5, 4, v6
    v_lshl_add_u32 v6, v5, 3, v6

    buffer_load_dwordx2 v[136:137], v6, s[24:27], s42 offen offset:0
    buffer_load_dwordx2 v[138:139], v6, s[24:27], s42 offen offset:16
    buffer_load_dwordx2 v[140:141], v6, s[24:27], s42 offen offset:32
    buffer_load_dwordx2 v[142:143], v6, s[24:27], s42 offen offset:48
    s_waitcnt vmcnt(12)
    v_mfma_f32_32x32x16_bf16 v[8:23], v[72:75], v[80:83], v[8:23]
    buffer_load_dwordx4 v[120:123], v3, s[12:15], s33 offen offset:3072
    v_mfma_f32_32x32x16_bf16 v[24:39], v[72:75], v[84:87], v[24:39]
    buffer_load_dwordx4 v[128:131], v3, s[16:19], s35 offen offset:3072
    v_mfma_f32_32x32x16_bf16 v[40:55], v[76:79], v[80:83], v[40:55]
    buffer_load_dwordx4 v[124:127], v3, s[12:15], s34 offen offset:3072
    v_mfma_f32_32x32x16_bf16 v[56:71], v[76:79], v[84:87], v[56:71]
    buffer_load_dwordx4 v[132:135], v3, s[16:19], s36 offen offset:3072
    s_add_u32 s33, s33, 4096
    s_add_u32 s34, s34, 4096
    s_add_u32 s35, s35, 4096
    s_add_u32 s36, s36, 4096
    s_waitcnt vmcnt(12)
    v_mfma_f32_32x32x16_bf16 v[8:23], v[88:91], v[96:99], v[8:23]
    buffer_load_dwordx4 v[72:75], v3, s[12:15], s33 offen offset:0
    v_mfma_f32_32x32x16_bf16 v[24:39], v[88:91], v[100:103], v[24:39]
    buffer_load_dwordx4 v[80:83], v3, s[16:19], s35 offen offset:0
    v_mfma_f32_32x32x16_bf16 v[40:55], v[92:95], v[96:99], v[40:55]
    buffer_load_dwordx4 v[76:79], v3, s[12:15], s34 offen offset:0
    v_mfma_f32_32x32x16_bf16 v[56:71], v[92:95], v[100:103], v[56:71]
    buffer_load_dwordx4 v[84:87], v3, s[16:19], s36 offen offset:0
    s_waitcnt vmcnt(12)
    v_mfma_f32_32x32x16_bf16 v[8:23], v[104:107], v[112:115], v[8:23]
    buffer_load_dwordx4 v[88:91], v3, s[12:15], s33 offen offset:1024
    v_mfma_f32_32x32x16_bf16 v[24:39], v[104:107], v[116:119], v[24:39]
    buffer_load_dwordx4 v[96:99], v3, s[16:19], s35 offen offset:1024
    v_mfma_f32_32x32x16_bf16 v[40:55], v[108:111], v[112:115], v[40:55]
    buffer_load_dwordx4 v[92:95], v3, s[12:15], s34 offen offset:1024
    v_mfma_f32_32x32x16_bf16 v[56:71], v[108:111], v[116:119], v[56:71]
    buffer_load_dwordx4 v[100:103], v3, s[16:19], s36 offen offset:1024
    s_waitcnt vmcnt(8)
    v_mfma_f32_32x32x16_bf16 v[8:23], v[120:123], v[128:131], v[8:23]
    buffer_load_dwordx4 v[104:107], v3, s[12:15], s33 offen offset:2048
    v_mfma_f32_32x32x16_bf16 v[24:39], v[120:123], v[132:135], v[24:39]
    buffer_load_dwordx4 v[112:115], v3, s[16:19], s35 offen offset:2048
    v_mfma_f32_32x32x16_bf16 v[40:55], v[124:127], v[128:131], v[40:55]
    buffer_load_dwordx4 v[108:111], v3, s[12:15], s34 offen offset:2048
    v_mfma_f32_32x32x16_bf16 v[56:71], v[124:127], v[132:135], v[56:71]
    buffer_load_dwordx4 v[116:119], v3, s[16:19], s36 offen offset:2048
    s_lshl_b32 s51, s10, 7
    s_add_u32 s51, s51, 17893376
    s_lshr_b32 s52, s8, 1
    s_lshl_b32 s52, s52, 6
    s_add_u32 s51, s51, s52
    v_and_b32 v153, 15, v1
    v_lshl_add_u32 v153, v153, 2, s51
    global_load_dword v154, v153, s[4:5] sc1

    s_waitcnt vmcnt(9)
    v_mfma_f32_32x32x16_bf16 v[8:23], v[72:75], v[80:83], v[8:23]
    buffer_load_dwordx4 v[120:123], v3, s[12:15], s33 offen offset:3072
    v_mfma_f32_32x32x16_bf16 v[24:39], v[72:75], v[84:87], v[24:39]
    buffer_load_dwordx4 v[128:131], v3, s[16:19], s35 offen offset:3072
    v_mfma_f32_32x32x16_bf16 v[40:55], v[76:79], v[80:83], v[40:55]
    buffer_load_dwordx4 v[124:127], v3, s[12:15], s34 offen offset:3072
    v_mfma_f32_32x32x16_bf16 v[56:71], v[76:79], v[84:87], v[56:71]
    buffer_load_dwordx4 v[132:135], v3, s[16:19], s36 offen offset:3072
    s_add_u32 s33, s33, 4096
    s_add_u32 s34, s34, 4096
    s_add_u32 s35, s35, 4096
    s_add_u32 s36, s36, 4096
    s_waitcnt vmcnt(9)
    v_mfma_f32_32x32x16_bf16 v[8:23], v[88:91], v[96:99], v[8:23]
    buffer_load_dwordx4 v[72:75], v3, s[12:15], s33 offen offset:0
    v_mfma_f32_32x32x16_bf16 v[24:39], v[88:91], v[100:103], v[24:39]
    buffer_load_dwordx4 v[80:83], v3, s[16:19], s35 offen offset:0
    v_mfma_f32_32x32x16_bf16 v[40:55], v[92:95], v[96:99], v[40:55]
    buffer_load_dwordx4 v[76:79], v3, s[12:15], s34 offen offset:0
    v_mfma_f32_32x32x16_bf16 v[56:71], v[92:95], v[100:103], v[56:71]
    buffer_load_dwordx4 v[84:87], v3, s[16:19], s36 offen offset:0
    s_waitcnt vmcnt(9)
    v_mfma_f32_32x32x16_bf16 v[8:23], v[104:107], v[112:115], v[8:23]
    buffer_load_dwordx4 v[88:91], v3, s[12:15], s33 offen offset:1024
    v_mfma_f32_32x32x16_bf16 v[24:39], v[104:107], v[116:119], v[24:39]
    buffer_load_dwordx4 v[96:99], v3, s[16:19], s35 offen offset:1024
    v_mfma_f32_32x32x16_bf16 v[40:55], v[108:111], v[112:115], v[40:55]
    buffer_load_dwordx4 v[92:95], v3, s[12:15], s34 offen offset:1024
    v_mfma_f32_32x32x16_bf16 v[56:71], v[108:111], v[116:119], v[56:71]
    buffer_load_dwordx4 v[100:103], v3, s[16:19], s36 offen offset:1024
    s_waitcnt vmcnt(8)
    v_mfma_f32_32x32x16_bf16 v[8:23], v[120:123], v[128:131], v[8:23]
    buffer_load_dwordx4 v[104:107], v3, s[12:15], s33 offen offset:2048
    v_mfma_f32_32x32x16_bf16 v[24:39], v[120:123], v[132:135], v[24:39]
    buffer_load_dwordx4 v[112:115], v3, s[16:19], s35 offen offset:2048
    v_mfma_f32_32x32x16_bf16 v[40:55], v[124:127], v[128:131], v[40:55]
    buffer_load_dwordx4 v[108:111], v3, s[12:15], s34 offen offset:2048
    v_mfma_f32_32x32x16_bf16 v[56:71], v[124:127], v[132:135], v[56:71]
    buffer_load_dwordx4 v[116:119], v3, s[16:19], s36 offen offset:2048
    s_waitcnt vmcnt(8)
    v_mfma_f32_32x32x16_bf16 v[8:23], v[72:75], v[80:83], v[8:23]
    buffer_load_dwordx4 v[120:123], v3, s[12:15], s33 offen offset:3072
    v_mfma_f32_32x32x16_bf16 v[24:39], v[72:75], v[84:87], v[24:39]
    buffer_load_dwordx4 v[128:131], v3, s[16:19], s35 offen offset:3072
    v_mfma_f32_32x32x16_bf16 v[40:55], v[76:79], v[80:83], v[40:55]
    buffer_load_dwordx4 v[124:127], v3, s[12:15], s34 offen offset:3072
    v_mfma_f32_32x32x16_bf16 v[56:71], v[76:79], v[84:87], v[56:71]
    buffer_load_dwordx4 v[132:135], v3, s[16:19], s36 offen offset:3072
    s_add_u32 s33, s33, 4096
    s_add_u32 s34, s34, 4096
    s_add_u32 s35, s35, 4096
    s_add_u32 s36, s36, 4096
    s_waitcnt vmcnt(20)
    v_cmp_eq_u32 vcc, 1, v154
    s_mov_b32 s51, 0
    s_nop 4
    s_cmp_eq_u64 vcc, -1
    s_cbranch_scc0 Lg2sk_2006
    s_mov_b32 s51, 1

    v_lshrrev_b32 v7, 2, v1
    v_and_b32 v152, 3, v1
    v_lshlrev_b32 v7, 12, v7
    v_lshl_add_u32 v7, v152, 4, v7
    s_lshl_b32 s43, s41, 12
    s_lshl_b32 s40, s39, 1
    s_add_u32 s43, s43, s40
    s_add_u32 s46, s43, 65536
    buffer_load_dwordx4 v[144:147], v7, s[20:23], s43 offen sc1
    buffer_load_dwordx4 v[148:151], v7, s[20:23], s46 offen sc1

Lg2sk_2006:
    s_waitcnt vmcnt(8)
    v_mfma_f32_32x32x16_bf16 v[8:23], v[88:91], v[96:99], v[8:23]
    buffer_load_dwordx4 v[72:75], v3, s[12:15], s33 offen offset:0
    v_mfma_f32_32x32x16_bf16 v[24:39], v[88:91], v[100:103], v[24:39]
    buffer_load_dwordx4 v[80:83], v3, s[16:19], s35 offen offset:0
    v_mfma_f32_32x32x16_bf16 v[40:55], v[92:95], v[96:99], v[40:55]
    buffer_load_dwordx4 v[76:79], v3, s[12:15], s34 offen offset:0
    v_mfma_f32_32x32x16_bf16 v[56:71], v[92:95], v[100:103], v[56:71]
    buffer_load_dwordx4 v[84:87], v3, s[16:19], s36 offen offset:0
    s_waitcnt vmcnt(8)
    v_mfma_f32_32x32x16_bf16 v[8:23], v[104:107], v[112:115], v[8:23]
    buffer_load_dwordx4 v[88:91], v3, s[12:15], s33 offen offset:1024
    v_mfma_f32_32x32x16_bf16 v[24:39], v[104:107], v[116:119], v[24:39]
    buffer_load_dwordx4 v[96:99], v3, s[16:19], s35 offen offset:1024
    v_mfma_f32_32x32x16_bf16 v[40:55], v[108:111], v[112:115], v[40:55]
    buffer_load_dwordx4 v[92:95], v3, s[12:15], s34 offen offset:1024
    v_mfma_f32_32x32x16_bf16 v[56:71], v[108:111], v[116:119], v[56:71]
    buffer_load_dwordx4 v[100:103], v3, s[16:19], s36 offen offset:1024
    s_waitcnt vmcnt(8)
    v_mfma_f32_32x32x16_bf16 v[8:23], v[120:123], v[128:131], v[8:23]
    buffer_load_dwordx4 v[104:107], v3, s[12:15], s33 offen offset:2048
    v_mfma_f32_32x32x16_bf16 v[24:39], v[120:123], v[132:135], v[24:39]
    buffer_load_dwordx4 v[112:115], v3, s[16:19], s35 offen offset:2048
    v_mfma_f32_32x32x16_bf16 v[40:55], v[124:127], v[128:131], v[40:55]
    buffer_load_dwordx4 v[108:111], v3, s[12:15], s34 offen offset:2048
    v_mfma_f32_32x32x16_bf16 v[56:71], v[124:127], v[132:135], v[56:71]
    buffer_load_dwordx4 v[116:119], v3, s[16:19], s36 offen offset:2048
    s_waitcnt vmcnt(8)
    v_mfma_f32_32x32x16_bf16 v[8:23], v[72:75], v[80:83], v[8:23]
    buffer_load_dwordx4 v[120:123], v3, s[12:15], s33 offen offset:3072
    v_mfma_f32_32x32x16_bf16 v[24:39], v[72:75], v[84:87], v[24:39]
    buffer_load_dwordx4 v[128:131], v3, s[16:19], s35 offen offset:3072
    v_mfma_f32_32x32x16_bf16 v[40:55], v[76:79], v[80:83], v[40:55]
    buffer_load_dwordx4 v[124:127], v3, s[12:15], s34 offen offset:3072
    v_mfma_f32_32x32x16_bf16 v[56:71], v[76:79], v[84:87], v[56:71]
    buffer_load_dwordx4 v[132:135], v3, s[16:19], s36 offen offset:3072
    s_waitcnt vmcnt(8)
    v_mfma_f32_32x32x16_bf16 v[8:23], v[88:91], v[96:99], v[8:23]
    v_mfma_f32_32x32x16_bf16 v[24:39], v[88:91], v[100:103], v[24:39]
    v_mfma_f32_32x32x16_bf16 v[40:55], v[92:95], v[96:99], v[40:55]
    v_mfma_f32_32x32x16_bf16 v[56:71], v[92:95], v[100:103], v[56:71]
    s_waitcnt vmcnt(4)
    v_mfma_f32_32x32x16_bf16 v[8:23], v[104:107], v[112:115], v[8:23]
    v_mfma_f32_32x32x16_bf16 v[24:39], v[104:107], v[116:119], v[24:39]
    v_mfma_f32_32x32x16_bf16 v[40:55], v[108:111], v[112:115], v[40:55]
    v_mfma_f32_32x32x16_bf16 v[56:71], v[108:111], v[116:119], v[56:71]
    s_waitcnt vmcnt(0)
    v_mfma_f32_32x32x16_bf16 v[8:23], v[120:123], v[128:131], v[8:23]
    v_mfma_f32_32x32x16_bf16 v[24:39], v[120:123], v[132:135], v[24:39]
    v_mfma_f32_32x32x16_bf16 v[40:55], v[124:127], v[128:131], v[40:55]
    v_mfma_f32_32x32x16_bf16 v[56:71], v[124:127], v[132:135], v[56:71]
    s_cmp_eq_u32 s51, 1
    s_cbranch_scc1 Lg2ok_2007
    s_mov_b32 s52, 0
Lg2sp_2008:
    global_load_dword v154, v153, s[4:5] sc1
    s_waitcnt vmcnt(0)
    v_cmp_eq_u32 vcc, 1, v154
    s_add_u32 s52, s52, 1
    s_nop 4
    s_cmp_eq_u64 vcc, -1
    s_cbranch_scc1 Lg2go_2009
    s_sleep 2
    s_cmp_lt_u32 s52, 20000
    s_cbranch_scc1 Lg2sp_2008
Lg2go_2009:

    v_lshrrev_b32 v7, 2, v1
    v_and_b32 v152, 3, v1
    v_lshlrev_b32 v7, 12, v7
    v_lshl_add_u32 v7, v152, 4, v7
    s_lshl_b32 s43, s41, 12
    s_lshl_b32 s40, s39, 1
    s_add_u32 s43, s43, s40
    s_add_u32 s46, s43, 65536
    buffer_load_dwordx4 v[144:147], v7, s[20:23], s43 offen sc1
    buffer_load_dwordx4 v[148:151], v7, s[20:23], s46 offen sc1

Lg2ok_2007:
    v_add_u32 v88, 0, v3
    s_cmp_eq_u32 s8, 0
    s_cbranch_scc1 Lg2r0_2010
    s_cmp_eq_u32 s8, 1
    s_cbranch_scc1 Lg2r1_2011
    s_cmp_eq_u32 s8, 2
    s_cbranch_scc1 Lg2r2_2012
    s_branch Lg2r3_2013
Lg2r0_2010:
    ds_write_b128 v88, v[24:27] offset:20480
    ds_write_b128 v88, v[28:31] offset:21504
    ds_write_b128 v88, v[32:35] offset:22528
    ds_write_b128 v88, v[36:39] offset:23552
    ds_write_b128 v88, v[40:43] offset:28672
    ds_write_b128 v88, v[44:47] offset:29696
    ds_write_b128 v88, v[48:51] offset:30720
    ds_write_b128 v88, v[52:55] offset:31744
    ds_write_b128 v88, v[56:59] offset:36864
    ds_write_b128 v88, v[60:63] offset:37888
    ds_write_b128 v88, v[64:67] offset:38912
    ds_write_b128 v88, v[68:71] offset:39936
    s_branch Lg2re_2014
Lg2r1_2011:
    ds_write_b128 v88, v[8:11] offset:0
    ds_write_b128 v88, v[12:15] offset:1024
    ds_write_b128 v88, v[16:19] offset:2048
    ds_write_b128 v88, v[20:23] offset:3072
    ds_write_b128 v88, v[40:43] offset:32768
    ds_write_b128 v88, v[44:47] offset:33792
    ds_write_b128 v88, v[48:51] offset:34816
    ds_write_b128 v88, v[52:55] offset:35840
    ds_write_b128 v88, v[56:59] offset:40960
    ds_write_b128 v88, v[60:63] offset:41984
    ds_write_b128 v88, v[64:67] offset:43008
    ds_write_b128 v88, v[68:71] offset:44032
    v_mov_b32 v8, v24
    v_mov_b32 v9, v25
    v_mov_b32 v10, v26
    v_mov_b32 v11, v27
    v_mov_b32 v12, v28
    v_mov_b32 v13, v29
    v_mov_b32 v14, v30
    v_mov_b32 v15, v31
    v_mov_b32 v16, v32
    v_mov_b32 v17, v33
    v_mov_b32 v18, v34
    v_mov_b32 v19, v35
    v_mov_b32 v20, v36
    v_mov_b32 v21, v37
    v_mov_b32 v22, v38
    v_mov_b32 v23, v39
    s_branch Lg2re_2014
Lg2r2_2012:
    ds_write_b128 v88, v[8:11] offset:4096
    ds_write_b128 v88, v[12:15] offset:5120
    ds_write_b128 v88, v[16:19] offset:6144
    ds_write_b128 v88, v[20:23] offset:7168
    ds_write_b128 v88, v[24:27] offset:12288
    ds_write_b128 v88, v[28:31] offset:13312
    ds_write_b128 v88, v[32:35] offset:14336
    ds_write_b128 v88, v[36:39] offset:15360
    ds_write_b128 v88, v[56:59] offset:45056
    ds_write_b128 v88, v[60:63] offset:46080
    ds_write_b128 v88, v[64:67] offset:47104
    ds_write_b128 v88, v[68:71] offset:48128
    v_mov_b32 v8, v40
    v_mov_b32 v9, v41
    v_mov_b32 v10, v42
    v_mov_b32 v11, v43
    v_mov_b32 v12, v44
    v_mov_b32 v13, v45
    v_mov_b32 v14, v46
    v_mov_b32 v15, v47
    v_mov_b32 v16, v48
    v_mov_b32 v17, v49
    v_mov_b32 v18, v50
    v_mov_b32 v19, v51
    v_mov_b32 v20, v52
    v_mov_b32 v21, v53
    v_mov_b32 v22, v54
    v_mov_b32 v23, v55
    s_branch Lg2re_2014
Lg2r3_2013:
    ds_write_b128 v88, v[8:11] offset:8192
    ds_write_b128 v88, v[12:15] offset:9216
    ds_write_b128 v88, v[16:19] offset:10240
    ds_write_b128 v88, v[20:23] offset:11264
    ds_write_b128 v88, v[24:27] offset:16384
    ds_write_b128 v88, v[28:31] offset:17408
    ds_write_b128 v88, v[32:35] offset:18432
    ds_write_b128 v88, v[36:39] offset:19456
    ds_write_b128 v88, v[40:43] offset:24576
    ds_write_b128 v88, v[44:47] offset:25600
    ds_write_b128 v88, v[48:51] offset:26624
    ds_write_b128 v88, v[52:55] offset:27648
    v_mov_b32 v8, v56
    v_mov_b32 v9, v57
    v_mov_b32 v10, v58
    v_mov_b32 v11, v59
    v_mov_b32 v12, v60
    v_mov_b32 v13, v61
    v_mov_b32 v14, v62
    v_mov_b32 v15, v63
    v_mov_b32 v16, v64
    v_mov_b32 v17, v65
    v_mov_b32 v18, v66
    v_mov_b32 v19, v67
    v_mov_b32 v20, v68
    v_mov_b32 v21, v69
    v_mov_b32 v22, v70
    v_mov_b32 v23, v71
    s_branch Lg2re_2014
Lg2re_2014:
    s_lshl_b32 s40, s8, 11
    s_add_u32 s40, s40, 49152
    v_add_u32 v89, s40, v3
    s_waitcnt vmcnt(0)
    ds_write_b128 v89, v[144:147]
    ds_write_b128 v89, v[148:151] offset:1024
    s_mul_i32 s47, s8, 12288
    v_add_u32 v88, s47, v88
    s_waitcnt lgkmcnt(0)

    s_barrier
    ds_read_b128 v[24:27], v88 offset:0
    ds_read_b128 v[28:31], v88 offset:1024
    ds_read_b128 v[32:35], v88 offset:2048
    ds_read_b128 v[36:39], v88 offset:3072
    ds_read_b128 v[40:43], v88 offset:4096
    ds_read_b128 v[44:47], v88 offset:5120
    ds_read_b128 v[48:51], v88 offset:6144
    ds_read_b128 v[52:55], v88 offset:7168
    ds_read_b128 v[56:59], v88 offset:8192
    ds_read_b128 v[60:63], v88 offset:9216
    ds_read_b128 v[64:67], v88 offset:10240
    ds_read_b128 v[68:71], v88 offset:11264
    v_lshrrev_b32 v90, 4, v1
    v_and_b32 v91, 15, v1
    v_lshrrev_b32 v92, 2, v91
    v_and_b32 v93, 3, v91
    v_lshrrev_b32 v94, 1, v90
    v_and_b32 v90, 1, v90
    v_lshl_add_u32 v92, v94, 2, v92
    v_lshlrev_b32 v92, 6, v92
    v_lshl_add_u32 v92, v90, 5, v92
    v_lshl_add_u32 v92, v93, 3, v92
    v_add_u32 v92, s40, v92

    ds_read_b64_tr_b16 v[96:97], v92 offset:0
    ds_read_b64_tr_b16 v[98:99], v92 offset:512
    ds_read_b64_tr_b16 v[100:101], v92 offset:1024
    ds_read_b64_tr_b16 v[102:103], v92 offset:1536
    s_waitcnt lgkmcnt(4)
    v_pk_add_f32 v[8:9], v[8:9], v[24:25]
    v_pk_add_f32 v[10:11], v[10:11], v[26:27]
    v_pk_add_f32 v[12:13], v[12:13], v[28:29]
    v_pk_add_f32 v[14:15], v[14:15], v[30:31]
    v_pk_add_f32 v[16:17], v[16:17], v[32:33]
    v_pk_add_f32 v[18:19], v[18:19], v[34:35]
    v_pk_add_f32 v[20:21], v[20:21], v[36:37]
    v_pk_add_f32 v[22:23], v[22:23], v[38:39]
    v_pk_add_f32 v[8:9], v[8:9], v[40:41]
    v_pk_add_f32 v[10:11], v[10:11], v[42:43]
    v_pk_add_f32 v[12:13], v[12:13], v[44:45]
    v_pk_add_f32 v[14:15], v[14:15], v[46:47]
    v_pk_add_f32 v[16:17], v[16:17], v[48:49]
    v_pk_add_f32 v[18:19], v[18:19], v[50:51]
    v_pk_add_f32 v[20:21], v[20:21], v[52:53]
    v_pk_add_f32 v[22:23], v[22:23], v[54:55]
    v_pk_add_f32 v[8:9], v[8:9], v[56:57]
    v_pk_add_f32 v[10:11], v[10:11], v[58:59]
    v_pk_add_f32 v[12:13], v[12:13], v[60:61]
    v_pk_add_f32 v[14:15], v[14:15], v[62:63]
    v_pk_add_f32 v[16:17], v[16:17], v[64:65]
    v_pk_add_f32 v[18:19], v[18:19], v[66:67]
    v_pk_add_f32 v[20:21], v[20:21], v[68:69]
    v_pk_add_f32 v[22:23], v[22:23], v[70:71]
    s_mov_b32 s40, 0x3fb8aa3b
    v_mul_f32 v24, s40, v8
    v_mul_f32 v25, s40, v9
    v_mul_f32 v26, s40, v10
    v_mul_f32 v27, s40, v11
    v_mul_f32 v28, s40, v12
    v_mul_f32 v29, s40, v13
    v_mul_f32 v30, s40, v14
    v_mul_f32 v31, s40, v15
    v_mul_f32 v32, s40, v16
    v_mul_f32 v33, s40, v17
    v_mul_f32 v34, s40, v18
    v_mul_f32 v35, s40, v19
    v_mul_f32 v36, s40, v20
    v_mul_f32 v37, s40, v21
    v_mul_f32 v38, s40, v22
    v_mul_f32 v39, s40, v23
    v_exp_f32 v24, -v24
    v_exp_f32 v25, -v25
    v_exp_f32 v26, -v26
    v_exp_f32 v27, -v27
    v_exp_f32 v28, -v28
    v_exp_f32 v29, -v29
    v_exp_f32 v30, -v30
    v_exp_f32 v31, -v31
    v_exp_f32 v32, -v32
    v_exp_f32 v33, -v33
    v_exp_f32 v34, -v34
    v_exp_f32 v35, -v35
    v_exp_f32 v36, -v36
    v_exp_f32 v37, -v37
    v_exp_f32 v38, -v38
    v_exp_f32 v39, -v39
    v_add_f32 v24, 1.0, v24
    v_add_f32 v25, 1.0, v25
    v_add_f32 v26, 1.0, v26
    v_add_f32 v27, 1.0, v27
    v_add_f32 v28, 1.0, v28
    v_add_f32 v29, 1.0, v29
    v_add_f32 v30, 1.0, v30
    v_add_f32 v31, 1.0, v31
    v_add_f32 v32, 1.0, v32
    v_add_f32 v33, 1.0, v33
    v_add_f32 v34, 1.0, v34
    v_add_f32 v35, 1.0, v35
    v_add_f32 v36, 1.0, v36
    v_add_f32 v37, 1.0, v37
    v_add_f32 v38, 1.0, v38
    v_add_f32 v39, 1.0, v39
    v_rcp_f32 v24, v24
    v_rcp_f32 v25, v25
    v_rcp_f32 v26, v26
    v_rcp_f32 v27, v27
    v_rcp_f32 v28, v28
    v_rcp_f32 v29, v29
    v_rcp_f32 v30, v30
    v_rcp_f32 v31, v31
    v_rcp_f32 v32, v32
    v_rcp_f32 v33, v33
    v_rcp_f32 v34, v34
    v_rcp_f32 v35, v35
    v_rcp_f32 v36, v36
    v_rcp_f32 v37, v37
    v_rcp_f32 v38, v38
    v_rcp_f32 v39, v39
    v_mul_f32 v8, v8, v24
    v_mul_f32 v9, v9, v25
    v_mul_f32 v10, v10, v26
    v_mul_f32 v11, v11, v27
    v_mul_f32 v12, v12, v28
    v_mul_f32 v13, v13, v29
    v_mul_f32 v14, v14, v30
    v_mul_f32 v15, v15, v31
    v_mul_f32 v16, v16, v32
    v_mul_f32 v17, v17, v33
    v_mul_f32 v18, v18, v34
    v_mul_f32 v19, v19, v35
    v_mul_f32 v20, v20, v36
    v_mul_f32 v21, v21, v37
    v_mul_f32 v22, v22, v38
    v_mul_f32 v23, v23, v39
    s_waitcnt lgkmcnt(0)
    v_lshlrev_b32 v40, 16, v96
    v_and_b32 v41, 0xffff0000, v96
    v_lshlrev_b32 v42, 16, v136
    v_and_b32 v43, 0xffff0000, v136
    v_fmac_f32 v42, v40, v8
    v_fmac_f32 v43, v41, v9
    v_cvt_pk_bf16_f32 v44, v42, v43
    v_lshlrev_b32 v40, 16, v97
    v_and_b32 v41, 0xffff0000, v97
    v_lshlrev_b32 v42, 16, v137
    v_and_b32 v43, 0xffff0000, v137
    v_fmac_f32 v42, v40, v10
    v_fmac_f32 v43, v41, v11
    v_cvt_pk_bf16_f32 v45, v42, v43
    v_lshlrev_b32 v40, 16, v98
    v_and_b32 v41, 0xffff0000, v98
    v_lshlrev_b32 v42, 16, v138
    v_and_b32 v43, 0xffff0000, v138
    v_fmac_f32 v42, v40, v12
    v_fmac_f32 v43, v41, v13
    v_cvt_pk_bf16_f32 v46, v42, v43
    v_lshlrev_b32 v40, 16, v99
    v_and_b32 v41, 0xffff0000, v99
    v_lshlrev_b32 v42, 16, v139
    v_and_b32 v43, 0xffff0000, v139
    v_fmac_f32 v42, v40, v14
    v_fmac_f32 v43, v41, v15
    v_cvt_pk_bf16_f32 v47, v42, v43
    s_nop 1
    v_permlane32_swap_b32 v44, v46
    v_permlane32_swap_b32 v45, v47
    buffer_store_dwordx4 v[44:47], v155, s[28:31], s42 offen offset:0
    v_lshlrev_b32 v40, 16, v100
    v_and_b32 v41, 0xffff0000, v100
    v_lshlrev_b32 v42, 16, v140
    v_and_b32 v43, 0xffff0000, v140
    v_fmac_f32 v42, v40, v16
    v_fmac_f32 v43, v41, v17
    v_cvt_pk_bf16_f32 v48, v42, v43
    v_lshlrev_b32 v40, 16, v101
    v_and_b32 v41, 0xffff0000, v101
    v_lshlrev_b32 v42, 16, v141
    v_and_b32 v43, 0xffff0000, v141
    v_fmac_f32 v42, v40, v18
    v_fmac_f32 v43, v41, v19
    v_cvt_pk_bf16_f32 v49, v42, v43
    v_lshlrev_b32 v40, 16, v102
    v_and_b32 v41, 0xffff0000, v102
    v_lshlrev_b32 v42, 16, v142
    v_and_b32 v43, 0xffff0000, v142
    v_fmac_f32 v42, v40, v20
    v_fmac_f32 v43, v41, v21
    v_cvt_pk_bf16_f32 v50, v42, v43
    v_lshlrev_b32 v40, 16, v103
    v_and_b32 v41, 0xffff0000, v103
    v_lshlrev_b32 v42, 16, v143
    v_and_b32 v43, 0xffff0000, v143
    v_fmac_f32 v42, v40, v22
    v_fmac_f32 v43, v41, v23
    v_cvt_pk_bf16_f32 v51, v42, v43
    s_nop 1
    v_permlane32_swap_b32 v48, v50
    v_permlane32_swap_b32 v49, v51
    buffer_store_dwordx4 v[48:51], v155, s[28:31], s42 offen offset:32
    s_endpgm
L1_end:
    s_endpgm
Lcode_end:
.section .rodata,"a"
.p2align 6
.amdhsa_kernel p0_kernel
  .amdhsa_next_free_vgpr 240
  .amdhsa_next_free_sgpr 102
  .amdhsa_accum_offset 240
  .amdhsa_group_segment_fixed_size 0
  .amdhsa_kernarg_size 112
  .amdhsa_user_sgpr_count 2
  .amdhsa_user_sgpr_kernarg_segment_ptr 1
  .amdhsa_system_sgpr_workgroup_id_x 1
.end_amdhsa_kernel
.p2align 6
.amdhsa_kernel p1_kernel
  .amdhsa_next_free_vgpr 248
  .amdhsa_next_free_sgpr 102
  .amdhsa_accum_offset 248
  .amdhsa_group_segment_fixed_size 0
  .amdhsa_kernarg_size 112
  .amdhsa_user_sgpr_count 2
  .amdhsa_user_sgpr_kernarg_segment_ptr 1
  .amdhsa_system_sgpr_workgroup_id_x 1
.end_amdhsa_kernel
```
